```python
import torch

def _softmax(x, axis=-1):
    return torch.softmax(x, dim=axis)
def _gelu(x):
    return torch.nn.functional.gelu(x, approximate="tanh")
def _silu(x):
    return torch.nn.functional.silu(x)
def _sigmoid(x):
    return torch.sigmoid(x)
def _layernorm(x, axis=-1, eps=1e-5):
    m = x.mean(dim=axis, keepdim=True)
    v = x.var(dim=axis, keepdim=True, unbiased=False)
    return (x - m) / torch.sqrt(v + eps)
def _scatter_add(tgt, idx, src, axis=0):
    return tgt.clone().index_add_(axis, idx, src)
def _segment_sum(src, seg, n):
    out = torch.zeros((n,) + src.shape[1:], dtype=src.dtype)
    return out.index_add_(0, seg, src)
def _pad(x, pw):
    flat = tuple(v for pair in reversed(pw) for v in pair)
    return torch.nn.functional.pad(x, flat)

kernel_name = 'parallel_sum__gqa_block_cached__glu_gated_geglu__decode'

def setup_inputs():

    _w = (lambda a: (lambda t: t.to(torch.bfloat16) if t.is_floating_point() else t)(torch.as_tensor(a)))
    def _A_setup():
        B, Sq, D = 1, 1, 576
        Hq, Hkv, Sk, Dh = 32, 16, 65536, 128
        assert Hq % Hkv == 0, (Hq, Hkv)
        return {
            "x": _w((lambda *s: torch.randn(*s, dtype=torch.bfloat16) * 0.05)(B, Sq, D)),
            "k_cache": _w((lambda *s: torch.randn(*s, dtype=torch.bfloat16) * 1.6)(B, Hkv, Sk, Dh)),
            "v_cache": _w((lambda *s: torch.randn(*s, dtype=torch.bfloat16) * 1.6)(B, Hkv, Sk, Dh)),
            "wq": _w((lambda *s: torch.randn(*s, dtype=torch.bfloat16) * 1.6)(D, Hq * Dh) * (D ** -0.5)),
            "wo": _w((lambda *s: torch.randn(*s, dtype=torch.bfloat16) * 1.6)(Hq * Dh, D) * ((Hq * Dh) ** -0.5)),
        }
    _A_in = _A_setup()

    def _B_setup():
        B, S, Dm, Df = 1, 1, 576, 4608
        return {
            "x": _w((lambda *s: torch.randn(*s, dtype=torch.bfloat16) * 0.05)(B, S, Dm)),
            "w_gate": _w((lambda *s: torch.randn(*s, dtype=torch.bfloat16) * 0.8)(Dm, Df) * (Dm ** -0.5)),
            "w_up": _w((lambda *s: torch.randn(*s, dtype=torch.bfloat16) * 0.8)(Dm, Df) * (Dm ** -0.5)),
            "w_down": _w((lambda *s: torch.randn(*s, dtype=torch.bfloat16) * 0.8)(Df, Dm) * (Df ** -0.5)),
        }
    _B_in = _B_setup()

    return {
        "A_x": _A_in["x"],
        "A_k_cache": _A_in["k_cache"],
        "A_v_cache": _A_in["v_cache"],
        "A_wq": _A_in["wq"],
        "A_wo": _A_in["wo"],
        "B_x": _B_in["x"],
        "B_w_gate": _B_in["w_gate"],
        "B_w_up": _B_in["w_up"],
        "B_w_down": _B_in["w_down"],
    }

def reference(A_x, A_k_cache, A_v_cache, A_wq, A_wo, B_x, B_w_gate, B_w_up, B_w_down):
    def _A_ref(x, k_cache, v_cache, wq, wo):
        B, Sq, D = x.shape
        Hq, Dh = 32, 128
        Hkv = k_cache.shape[1]
        rep = Hq // Hkv
        q = (lambda x, *d: x.permute(*d))((x @ wq).reshape(B, Sq, Hq, Dh), 0, 2, 1, 3)
        k = (lambda x, n, axis: torch.repeat_interleave(x, n, dim=axis))(k_cache, rep, axis=1)
        v = (lambda x, n, axis: torch.repeat_interleave(x, n, dim=axis))(v_cache, rep, axis=1)
        scores = torch.einsum("bhqd,bhkd->bhqk", q, k) * (Dh ** -0.5)
        p = _softmax(scores, axis=-1)
        o = torch.einsum("bhqk,bhkd->bhqd", p, v)
        return (lambda x, *d: x.permute(*d))(o, 0, 2, 1, 3).reshape(B, Sq, Hq * Dh) @ wo

    def _B_ref(x, w_gate, w_up, w_down):
        g = torch.einsum("bsd,df->bsf", x, w_gate)
        u = torch.einsum("bsd,df->bsf", x, w_up)
        h = _gelu(g) * u
        return torch.einsum("bsf,fd->bsd", h, w_down)

    x = A_x
    xn = _layernorm(x, axis=-1)
    return x + _A_ref(xn, A_k_cache, A_v_cache, A_wq, A_wo) + _B_ref(xn, B_w_gate, B_w_up, B_w_down)
```

```asm
; @launch grid=(256,1,1) block=(256,1,1) lds=29952
.amdgcn_target "amdgcn-amd-amdhsa--gfx950"
.text
.globl parallel_sum__gqa_block_cached__glu_gated_geglu__decode_kernel
.p2align 8
.type parallel_sum__gqa_block_cached__glu_gated_geglu__decode_kernel,@function
parallel_sum__gqa_block_cached__glu_gated_geglu__decode_kernel:

  s_cmp_ge_u32 s2, 256
  s_cbranch_scc1 parallel_sum__gqa_block_cached__glu_gated_geglu__decode_kernel_endx
  s_load_dwordx16 s[8:23], s[0:1], 0
  s_load_dwordx8 s[24:31], s[0:1], 64
  v_mov_b32 v31, 0
  ds_write_b32 v31, v31 offset:29824
  v_mov_b32 v1, v0
  v_and_b32 v0, 63, v0
  v_lshrrev_b32 v253, 6, v1
  s_lshr_b32 s3, s2, 4
  v_readfirstlane_b32 s5, v253
  s_and_b32 s4, s2, 15
  v_and_b32 v192, 15, v0
  v_lshrrev_b32 v193, 4, v0
  v_lshlrev_b32 v2, 8, v192
  v_lshl_add_u32 v2, v193, 4, v2
  v_lshlrev_b32 v3, 10, v193
  v_lshl_add_u32 v3, v192, 4, v3
  v_lshlrev_b32 v248, 4, v0
  v_bfe_u32 v194, v0, 3, 1
  v_lshl_add_u32 v194, v193, 1, v194
  v_lshlrev_b32 v249, 1, v194
  v_lshlrev_b32 v255, 2, v194
  v_and_b32 v253, 7, v0
  v_lshlrev_b32 v253, 4, v253
  v_lshl_add_u32 v250, v194, 13, v253
  v_mul_u32_u24 v254, 9216, v194
  v_add_u32 v254, v254, v253
  v_mul_u32_u24 v251, 1152, v193
  v_lshl_add_u32 v251, v192, 4, v251
  v_mov_b32 v252, 0x7fff0000
  v_cmp_gt_u32 vcc, 8, v192
  s_lshr_b32 s62, s4, 2
  s_and_b32 s63, s4, 3
  v_cndmask_b32 v252, v252, v251, vcc
  s_mul_i32 s64, s62, 1179648
  s_lshl_b32 s66, s3, 9
  s_add_u32 s64, s64, s66
  s_lshl_b32 s66, s63, 7
  s_add_u32 s64, s64, s66
  s_mul_i32 s66, s62, 288
  s_lshl_b32 s67, s5, 4
  s_add_u32 s66, s66, s67
  s_lshl_b32 s67, s5, 16
  s_add_u32 s69, s4, s3
  s_and_b32 s69, s69, 15
  s_bitcmp1_b32 s3, 0
  s_mov_b32 s6, 27
  s_cselect_b32 s6, 19, s6
  s_lshr_b32 s70, s3, 1
  s_cmp_eq_u32 s70, 3
  s_mov_b32 s7, 16
  s_cselect_b32 s7, 24, s7
  s_cmp_lt_u32 s69, 5
  s_cselect_b32 s59, 1, 0
  s_mov_b32 s71, 252
  s_sub_u32 s70, 252, s7
  s_cmp_eq_u32 s69, 4
  s_cselect_b32 s71, s70, s71
  s_cselect_b32 s60, 1, 0
  s_sub_u32 s70, 252, s6
  s_cmp_eq_u32 s69, 3
  s_cselect_b32 s71, s70, s71
  s_cmp_lt_u32 s69, 3
  s_cselect_b32 s71, 233, s71
  s_sub_u32 s53, s71, s5
  s_add_u32 s53, s53, 3
  s_lshr_b32 s53, s53, 2
  s_lshl_b32 s52, s69, 20
  s_lshl_b32 s70, s5, 12
  s_add_u32 s52, s52, s70
  s_lshl_b32 s70, s3, 2
  s_add_u32 s70, s70, s69
  s_lshl_b32 s70, s70, 6
  s_lshl_b32 s71, s3, 5
  s_add_u32 s71, s71, 4096
  s_cmp_eq_u32 s60, 1
  s_cselect_b32 s54, s71, s70
  s_lshl_b32 s70, s3, 24
  s_waitcnt lgkmcnt(0)
  s_load_dwordx2 s[78:79], s[30:31], 0
  s_mov_b32 s40, s30
  s_mov_b32 s41, s31
  s_mov_b32 s42, 3932160
  s_mov_b32 s43, 0x20000
  s_lshl_b32 s71, s3, 8
  s_add_u32 s71, s71, 163840
  s_or_b32 s69, s4, s5
  s_cmp_eq_u32 s69, 0
  s_cselect_b32 s69, s71, 0x7fff0000
  v_mov_b32 v88, 0x7fff0000
  v_mov_b32 v89, s69
  v_cmp_eq_u32 vcc, 0, v0
  v_mov_b32 v90, 0
  v_mov_b32 v91, s71
  v_cndmask_b32 v89, v88, v89, vcc
  v_cndmask_b32 v31, v88, v91, vcc
  buffer_store_dword v90, v89, s[40:43], 0 offen sc1
  s_mov_b32 s44, s8
  s_mov_b32 s45, s9
  s_mov_b32 s46, 1152
  s_mov_b32 s47, 0x20000
  s_add_u32 s48, s14, s64
  s_addc_u32 s49, s15, 0
  s_mov_b32 s50, 1171584
  s_mov_b32 s51, 0x20000
  buffer_load_dwordx4 v[80:83], v248, s[44:47], 0 offen
  buffer_load_dwordx4 v[84:87], v248, s[44:47], 0 offen offset:1024
  buffer_load_ushort v216, v249, s[44:47], s66 offen offset:0
  buffer_load_ushort v217, v249, s[44:47], s66 offen offset:64
  buffer_load_ushort v218, v249, s[44:47], s66 offen offset:128
  buffer_load_ushort v219, v249, s[44:47], s66 offen offset:192
  buffer_load_ushort v220, v249, s[44:47], s66 offen offset:256
  buffer_load_dwordx4 v[224:227], v250, s[48:51], s67 offen nt
  s_add_u32 s67, s67, 262144
  buffer_load_dwordx4 v[228:231], v250, s[48:51], s67 offen nt
  s_add_u32 s67, s67, 262144
  buffer_load_dwordx4 v[232:235], v250, s[48:51], s67 offen nt
  s_add_u32 s67, s67, 262144
  buffer_load_dwordx4 v[236:239], v250, s[48:51], s67 offen nt
  s_add_u32 s67, s67, 262144
  buffer_load_dwordx4 v[240:243], v250, s[48:51], s67 offen nt
  s_barrier
  s_add_u32 s32, s10, s70
  s_addc_u32 s33, s11, 0
  s_mov_b32 s34, 16777216
  s_mov_b32 s35, 0x20000
  s_add_u32 s36, s12, s70
  s_addc_u32 s37, s13, 0
  s_mov_b32 s38, 16777216
  s_mov_b32 s39, 0x20000
  buffer_load_dwordx4 v[96:99], v2, s[32:35], s52 offen offset:0 nt
  buffer_load_dwordx4 v[100:103], v2, s[32:35], s52 offen offset:64 nt
  buffer_load_dwordx4 v[104:107], v2, s[32:35], s52 offen offset:128 nt
  buffer_load_dwordx4 v[108:111], v2, s[32:35], s52 offen offset:192 nt
  buffer_load_dwordx4 v[112:115], v3, s[36:39], s52 offen offset:0 nt
  buffer_load_dwordx4 v[116:119], v3, s[36:39], s52 offen offset:256 nt
  buffer_load_dwordx4 v[120:123], v3, s[36:39], s52 offen offset:512 nt
  buffer_load_dwordx4 v[124:127], v3, s[36:39], s52 offen offset:768 nt
  s_add_u32 s52, s52, 16384
  s_mov_b32 s56, 0x3db504f3
  s_mov_b32 s57, 0x3db504f3
  s_mov_b32 s58, 0x3fb8aa3b
  v_and_b32 v192, 1, v0
  v_mov_b32 v193, 0xffff
  v_lshlrev_b32 v192, 4, v192
  v_lshlrev_b32 v193, v192, v193
  v_bfe_u32 v192, v0, 1, 2
  v_cmp_eq_u32 vcc, 0, v192
  s_nop 1
  v_cndmask_b32 v4, 0, v193, vcc
  v_cmp_eq_u32 vcc, 1, v192
  s_nop 1
  v_cndmask_b32 v5, 0, v193, vcc
  v_cmp_eq_u32 vcc, 2, v192
  s_nop 1
  v_cndmask_b32 v6, 0, v193, vcc
  v_cmp_eq_u32 vcc, 3, v192
  s_nop 1
  v_cndmask_b32 v7, 0, v193, vcc
  v_mov_b32 v24, 0
  v_mov_b32 v25, 0
  v_mov_b32 v26, 0
  v_mov_b32 v27, 0
  v_mov_b32 v56, 0
  v_mov_b32 v57, 0
  v_mov_b32 v58, 0
  v_mov_b32 v59, 0
  v_mov_b32 v60, 0
  v_mov_b32 v61, 0
  v_mov_b32 v62, 0
  v_mov_b32 v63, 0
  v_mov_b32 v64, 0
  v_mov_b32 v65, 0
  v_mov_b32 v66, 0
  v_mov_b32 v67, 0
  v_mov_b32 v68, 0
  v_mov_b32 v69, 0
  v_mov_b32 v70, 0
  v_mov_b32 v71, 0
  v_mov_b32 v72, 0
  v_mov_b32 v73, 0
  v_mov_b32 v74, 0
  v_mov_b32 v75, 0
  v_mov_b32 v28, 0xff800000
  v_mov_b32 v29, 0xff800000
  v_mov_b32 v30, 0
  s_waitcnt lgkmcnt(0)
  s_mul_i32 s76, s78, 1664525
  s_add_u32 s76, s76, 1013904223
  s_mul_i32 s77, s79, 22695477
  s_add_u32 s77, s77, 1
  s_waitcnt vmcnt(18)
  v_lshlrev_b32 v192, 16, v80
  v_and_b32 v193, 0xffff0000, v80
  v_lshlrev_b32 v200, 16, v84
  v_and_b32 v201, 0xffff0000, v84
  v_lshlrev_b32 v194, 16, v81
  v_and_b32 v195, 0xffff0000, v81
  v_lshlrev_b32 v202, 16, v85
  v_and_b32 v203, 0xffff0000, v85
  v_lshlrev_b32 v196, 16, v82
  v_and_b32 v197, 0xffff0000, v82
  v_lshlrev_b32 v204, 16, v86
  v_and_b32 v205, 0xffff0000, v86
  v_lshlrev_b32 v198, 16, v83
  v_and_b32 v199, 0xffff0000, v83
  v_lshlrev_b32 v206, 16, v87
  v_and_b32 v207, 0xffff0000, v87
  v_pk_add_f32 v[88:89], v[192:193], v[194:195]
  v_pk_add_f32 v[90:91], v[196:197], v[198:199]
  v_pk_add_f32 v[88:89], v[88:89], v[200:201]
  v_pk_add_f32 v[90:91], v[90:91], v[202:203]
  v_pk_add_f32 v[88:89], v[88:89], v[204:205]
  v_pk_add_f32 v[90:91], v[90:91], v[206:207]
  v_pk_add_f32 v[88:89], v[88:89], v[90:91]
  v_add_f32 v208, v88, v89
  s_nop 1
  v_add_f32_dpp v208, v208, v208 quad_perm:[1,0,3,2] row_mask:0xf bank_mask:0xf
  s_nop 1
  v_add_f32_dpp v208, v208, v208 quad_perm:[2,3,0,1] row_mask:0xf bank_mask:0xf
  s_nop 1
  v_add_f32_dpp v208, v208, v208 row_half_mirror row_mask:0xf bank_mask:0xf
  s_nop 1
  v_add_f32_dpp v208, v208, v208 row_mirror row_mask:0xf bank_mask:0xf
  v_mov_b32 v209, v208
  s_nop 1
  v_permlane16_swap_b32 v208, v209
  s_nop 1
  v_add_f32 v208, v208, v209
  v_mov_b32 v209, v208
  s_nop 1
  v_permlane32_swap_b32 v208, v209
  s_nop 1
  v_add_f32 v208, v208, v209
  v_mul_f32 v210, 0x3ae38e39, v208
  v_pk_add_f32 v[90:91], v[192:193], v[210:211] op_sel_hi:[1,0] neg_lo:[0,1] neg_hi:[0,1]
  v_pk_mul_f32 v[88:89], v[90:91], v[90:91]
  v_pk_add_f32 v[90:91], v[194:195], v[210:211] op_sel_hi:[1,0] neg_lo:[0,1] neg_hi:[0,1]
  v_pk_fma_f32 v[88:89], v[90:91], v[90:91], v[88:89]
  v_pk_add_f32 v[90:91], v[196:197], v[210:211] op_sel_hi:[1,0] neg_lo:[0,1] neg_hi:[0,1]
  v_pk_fma_f32 v[88:89], v[90:91], v[90:91], v[88:89]
  v_pk_add_f32 v[90:91], v[198:199], v[210:211] op_sel_hi:[1,0] neg_lo:[0,1] neg_hi:[0,1]
  v_pk_fma_f32 v[88:89], v[90:91], v[90:91], v[88:89]
  s_mov_b32 exec_lo, 0xff
  s_mov_b32 exec_hi, 0
  v_pk_add_f32 v[90:91], v[200:201], v[210:211] op_sel_hi:[1,0] neg_lo:[0,1] neg_hi:[0,1]
  v_pk_fma_f32 v[88:89], v[90:91], v[90:91], v[88:89]
  v_pk_add_f32 v[90:91], v[202:203], v[210:211] op_sel_hi:[1,0] neg_lo:[0,1] neg_hi:[0,1]
  v_pk_fma_f32 v[88:89], v[90:91], v[90:91], v[88:89]
  v_pk_add_f32 v[90:91], v[204:205], v[210:211] op_sel_hi:[1,0] neg_lo:[0,1] neg_hi:[0,1]
  v_pk_fma_f32 v[88:89], v[90:91], v[90:91], v[88:89]
  v_pk_add_f32 v[90:91], v[206:207], v[210:211] op_sel_hi:[1,0] neg_lo:[0,1] neg_hi:[0,1]
  v_pk_fma_f32 v[88:89], v[90:91], v[90:91], v[88:89]
  s_mov_b64 exec, -1
  v_add_f32 v208, v88, v89
  s_nop 1
  v_add_f32_dpp v208, v208, v208 quad_perm:[1,0,3,2] row_mask:0xf bank_mask:0xf
  s_nop 1
  v_add_f32_dpp v208, v208, v208 quad_perm:[2,3,0,1] row_mask:0xf bank_mask:0xf
  s_nop 1
  v_add_f32_dpp v208, v208, v208 row_half_mirror row_mask:0xf bank_mask:0xf
  s_nop 1
  v_add_f32_dpp v208, v208, v208 row_mirror row_mask:0xf bank_mask:0xf
  v_mov_b32 v209, v208
  s_nop 1
  v_permlane16_swap_b32 v208, v209
  s_nop 1
  v_add_f32 v208, v208, v209
  v_mov_b32 v209, v208
  s_nop 1
  v_permlane32_swap_b32 v208, v209
  s_nop 1
  v_add_f32 v208, v208, v209
  v_mul_f32 v208, 0x3ae38e39, v208
  v_cvt_pk_bf16_f32 v208, v208, v208
  v_and_b32 v208, 0xffff0000, v208
  v_add_f32 v208, 0x3727c5ac, v208
  v_cvt_pk_bf16_f32 v208, v208, v208
  v_and_b32 v208, 0xffff0000, v208
  v_sqrt_f32 v211, v208
  v_cvt_pk_bf16_f32 v210, v210, v210
  v_and_b32 v210, 0xffff0000, v210
  v_cvt_pk_bf16_f32 v211, v211, v211
  v_and_b32 v211, 0xffff0000, v211
  v_rcp_f32 v212, v211
  s_waitcnt vmcnt(13)
  v_lshlrev_b32 v216, 16, v216
  v_lshlrev_b32 v217, 16, v217
  v_lshlrev_b32 v218, 16, v218
  v_lshlrev_b32 v219, 16, v219
  v_lshlrev_b32 v220, 16, v220
  v_sub_f32 v216, v216, v210
  v_cvt_pk_bf16_f32 v216, v216, v216
  v_and_b32 v216, 0xffff0000, v216
  v_mul_f32 v213, v216, v212
  v_fma_f32 v214, -v213, v211, v216
  v_fma_f32 v213, v214, v212, v213
  v_cvt_pk_bf16_f32 v216, v213, v213
  v_sub_f32 v217, v217, v210
  v_cvt_pk_bf16_f32 v217, v217, v217
  v_and_b32 v217, 0xffff0000, v217
  v_mul_f32 v213, v217, v212
  v_fma_f32 v214, -v213, v211, v217
  v_fma_f32 v213, v214, v212, v213
  v_cvt_pk_bf16_f32 v217, v213, v213
  v_sub_f32 v218, v218, v210
  v_cvt_pk_bf16_f32 v218, v218, v218
  v_and_b32 v218, 0xffff0000, v218
  v_mul_f32 v213, v218, v212
  v_fma_f32 v214, -v213, v211, v218
  v_fma_f32 v213, v214, v212, v213
  v_cvt_pk_bf16_f32 v218, v213, v213
  v_sub_f32 v219, v219, v210
  v_cvt_pk_bf16_f32 v219, v219, v219
  v_and_b32 v219, 0xffff0000, v219
  v_mul_f32 v213, v219, v212
  v_fma_f32 v214, -v213, v211, v219
  v_fma_f32 v213, v214, v212, v213
  v_cvt_pk_bf16_f32 v219, v213, v213
  v_sub_f32 v220, v220, v210
  v_cvt_pk_bf16_f32 v220, v220, v220
  v_and_b32 v220, 0xffff0000, v220
  v_mul_f32 v213, v220, v212
  v_fma_f32 v214, -v213, v211, v220
  v_fma_f32 v213, v214, v212, v213
  v_cvt_pk_bf16_f32 v220, v213, v213
  s_waitcnt vmcnt(8)
  v_and_b32 v48, v216, v4
  v_and_b32 v49, v216, v5
  v_and_b32 v50, v216, v6
  v_and_b32 v51, v216, v7
  s_nop 1
  v_mfma_f32_16x16x32_bf16 v[244:247], v[48:51], v[224:227], 0
  v_and_b32 v52, v217, v4
  v_and_b32 v53, v217, v5
  v_and_b32 v54, v217, v6
  v_and_b32 v55, v217, v7
  s_nop 1
  v_mfma_f32_16x16x32_bf16 v[244:247], v[52:55], v[228:231], v[244:247]
  v_and_b32 v48, v218, v4
  v_and_b32 v49, v218, v5
  v_and_b32 v50, v218, v6
  v_and_b32 v51, v218, v7
  s_nop 1
  v_mfma_f32_16x16x32_bf16 v[244:247], v[48:51], v[232:235], v[244:247]
  v_and_b32 v52, v219, v4
  v_and_b32 v53, v219, v5
  v_and_b32 v54, v219, v6
  v_and_b32 v55, v219, v7
  s_nop 1
  v_mfma_f32_16x16x32_bf16 v[244:247], v[52:55], v[236:239], v[244:247]
  v_and_b32 v48, v220, v4
  v_and_b32 v49, v220, v5
  v_and_b32 v50, v220, v6
  v_and_b32 v51, v220, v7
  s_nop 1
  v_mfma_f32_16x16x32_bf16 v[244:247], v[48:51], v[240:243], v[244:247]
  v_and_b32 v88, 7, v0
  v_lshlrev_b32 v88, 5, v88
  v_bfe_u32 v89, v0, 4, 1
  v_lshl_add_u32 v88, v89, 4, v88
  v_bfe_u32 v89, v0, 3, 1
  v_lshl_add_u32 v88, v89, 8, v88
  s_lshl_b32 s63, s5, 9
  v_add_u32 v88, s63, v88
  s_mov_b32 exec_lo, 0x00ff00ff
  s_mov_b32 exec_hi, 0xff00ff00
  s_nop 0
  ds_write_b128 v88, v[244:247] offset:2560
  s_mov_b64 exec, -1
  s_waitcnt lgkmcnt(0)
  s_barrier
  s_cmp_eq_u32 s5, 0
  s_cbranch_scc0 L_pubq_done
  v_lshlrev_b32 v88, 3, v0
  ds_read_b64 v[224:225], v88 offset:2560
  ds_read_b64 v[226:227], v88 offset:2816
  ds_read_b64 v[228:229], v88 offset:3072
  ds_read_b64 v[230:231], v88 offset:3328
  ds_read_b64 v[232:233], v88 offset:3584
  ds_read_b64 v[234:235], v88 offset:3840
  ds_read_b64 v[236:237], v88 offset:4096
  ds_read_b64 v[238:239], v88 offset:4352
  v_lshlrev_b32 v89, 4, v0
  v_mov_b32 v90, 0x7fff0000
  v_cmp_gt_u32 vcc, 32, v0
  s_lshl_b32 s63, s2, 9
  s_add_u32 s63, s63, 4096
  v_cndmask_b32 v89, v90, v89, vcc
  s_waitcnt lgkmcnt(0)
  v_pk_add_f32 v[224:225], v[224:225], v[232:233]
  v_pk_add_f32 v[226:227], v[226:227], v[234:235]
  v_pk_add_f32 v[228:229], v[228:229], v[236:237]
  v_pk_add_f32 v[230:231], v[230:231], v[238:239]
  v_pk_add_f32 v[224:225], v[224:225], v[228:229]
  v_pk_add_f32 v[226:227], v[226:227], v[230:231]
  v_pk_add_f32 v[224:225], v[224:225], v[226:227]
  v_mov_b32 v226, v225
  v_mov_b32 v225, s76
  v_mov_b32 v227, s77
  buffer_store_dwordx4 v[224:227], v89, s[40:43], s63 offen sc1
L_pubq_done:
  s_barrier
  v_lshrrev_b32 v92, 4, v0
  v_lshlrev_b32 v92, 9, v92
  v_and_b32 v93, 15, v0
  v_lshl_add_u32 v92, v93, 5, v92
  s_lshl_b32 s72, s3, 13
  s_lshl_b32 s63, s5, 11
  s_add_u32 s72, s72, s63
  s_add_u32 s72, s72, 4096
  s_cmp_eq_u32 s59, 1
  s_cbranch_scc1 L_ffn_pro
  buffer_load_dwordx4 v[128:131], v2, s[32:35], s52 offen offset:0 nt
  buffer_load_dwordx4 v[132:135], v2, s[32:35], s52 offen offset:64 nt
  buffer_load_dwordx4 v[136:139], v2, s[32:35], s52 offen offset:128 nt
  buffer_load_dwordx4 v[140:143], v2, s[32:35], s52 offen offset:192 nt
  buffer_load_dwordx4 v[144:147], v3, s[36:39], s52 offen offset:0 nt
  buffer_load_dwordx4 v[148:151], v3, s[36:39], s52 offen offset:256 nt
  buffer_load_dwordx4 v[152:155], v3, s[36:39], s52 offen offset:512 nt
  buffer_load_dwordx4 v[156:159], v3, s[36:39], s52 offen offset:768 nt
  s_add_u32 s52, s52, 16384
  buffer_load_dwordx4 v[224:227], v92, s[40:43], s72 offen sc1
  buffer_load_dwordx4 v[228:231], v92, s[40:43], s72 offen offset:16 sc1
  s_waitcnt vmcnt(0)
  s_mov_b32 s55, 400000
L_qa_chk:
  v_xor_b32 v94, s76, v225
  v_xor_b32 v95, s77, v227
  v_or_b32 v94, v94, v95
  v_xor_b32 v95, s76, v229
  v_or_b32 v94, v94, v95
  v_xor_b32 v95, s77, v231
  v_or_b32 v94, v94, v95
  v_cmp_ne_u32 vcc, 0, v94
  s_cbranch_vccz L_qa_ok
  s_sub_u32 s55, s55, 1
  s_cmp_eq_u32 s55, 0
  s_cbranch_scc1 parallel_sum__gqa_block_cached__glu_gated_geglu__decode_kernel_end
  buffer_load_dwordx4 v[224:227], v92, s[40:43], s72 offen sc1
  buffer_load_dwordx4 v[228:231], v92, s[40:43], s72 offen offset:16 sc1
  s_waitcnt vmcnt(0)
  s_branch L_qa_chk
L_qa_ok:
  v_mov_b32 v225, v226
  v_mov_b32 v226, v228
  v_mov_b32 v227, v230
  v_lshlrev_b32 v94, 4, v1
  ds_write_b128 v94, v[224:227] offset:4608
  s_waitcnt lgkmcnt(0)
  s_barrier
  v_lshlrev_b32 v94, 4, v0
  ds_read_b128 v[224:227], v94 offset:4608
  ds_read_b128 v[228:231], v94 offset:5632
  ds_read_b128 v[232:235], v94 offset:6656
  ds_read_b128 v[236:239], v94 offset:7680
  s_lshl_b32 s63, s5, 9
  v_lshlrev_b32 v95, 3, v0
  v_add_u32 v95, s63, v95
  s_waitcnt lgkmcnt(0)
  v_pk_add_f32 v[224:225], v[224:225], v[228:229]
  v_pk_add_f32 v[232:233], v[232:233], v[236:237]
  v_pk_add_f32 v[226:227], v[226:227], v[230:231]
  v_pk_add_f32 v[234:235], v[234:235], v[238:239]
  v_pk_add_f32 v[224:225], v[224:225], v[232:233]
  v_pk_add_f32 v[226:227], v[226:227], v[234:235]
  v_cvt_pk_bf16_f32 v224, v224, v225
  v_cvt_pk_bf16_f32 v225, v226, v227
  ds_write_b64 v95, v[224:225] offset:8704
  v_bfe_u32 v94, v0, 3, 1
  v_lshlrev_b32 v94, 8, v94
  v_lshrrev_b32 v95, 4, v0
  v_lshl_add_u32 v94, v95, 4, v94
  v_add_u32 v94, s63, v94
  ds_read_b128 v[8:11], v94 offset:8704
  ds_read_b128 v[12:15], v94 offset:8768
  ds_read_b128 v[16:19], v94 offset:8832
  ds_read_b128 v[20:23], v94 offset:8896
  s_waitcnt lgkmcnt(0)
  s_branch L_preloop
L_ffn_pro:
  s_lshl_b32 s64, s54, 1
  s_add_u32 s44, s20, s64
  s_addc_u32 s45, s21, 0
  s_mov_b32 s46, 5299328
  s_mov_b32 s47, 0x20000
  s_add_u32 s48, s22, s64
  s_addc_u32 s49, s23, 0
  s_mov_b32 s50, 5299328
  s_mov_b32 s51, 0x20000
  v_and_b32 v88, 7, v0
  v_cmp_lt_u32 vcc, 3, v88
  s_cmp_eq_u32 s60, 1
  s_cselect_b64 s[68:69], vcc, 0
  v_mov_b32 v88, 0x7fff0000
  v_cndmask_b32 v254, v254, v88, s[68:69]
  s_mul_i32 s63, s5, 1327104
  buffer_load_dwordx4 a[0:3], v254, s[44:47], s63 offen nt
  buffer_load_dwordx4 a[72:75], v254, s[48:51], s63 offen nt
  s_add_u32 s63, s63, 73728
  buffer_load_dwordx4 a[4:7], v254, s[44:47], s63 offen nt
  buffer_load_dwordx4 a[76:79], v254, s[48:51], s63 offen nt
  s_add_u32 s63, s63, 73728
  buffer_load_dwordx4 a[8:11], v254, s[44:47], s63 offen nt
  buffer_load_dwordx4 a[80:83], v254, s[48:51], s63 offen nt
  s_add_u32 s63, s63, 73728
  buffer_load_dwordx4 a[12:15], v254, s[44:47], s63 offen nt
  buffer_load_dwordx4 a[84:87], v254, s[48:51], s63 offen nt
  s_add_u32 s63, s63, 73728
  buffer_load_dwordx4 a[16:19], v254, s[44:47], s63 offen nt
  buffer_load_dwordx4 a[88:91], v254, s[48:51], s63 offen nt
  s_add_u32 s63, s63, 73728
  buffer_load_dwordx4 a[20:23], v254, s[44:47], s63 offen nt
  buffer_load_dwordx4 a[92:95], v254, s[48:51], s63 offen nt
  s_add_u32 s63, s63, 73728
  buffer_load_dwordx4 a[24:27], v254, s[44:47], s63 offen nt
  buffer_load_dwordx4 a[96:99], v254, s[48:51], s63 offen nt
  s_add_u32 s63, s63, 73728
  buffer_load_dwordx4 a[28:31], v254, s[44:47], s63 offen nt
  buffer_load_dwordx4 a[100:103], v254, s[48:51], s63 offen nt
  s_add_u32 s63, s63, 73728
  buffer_load_dwordx4 a[32:35], v254, s[44:47], s63 offen nt
  buffer_load_dwordx4 a[104:107], v254, s[48:51], s63 offen nt
  s_add_u32 s63, s63, 73728
  buffer_load_dwordx4 a[36:39], v254, s[44:47], s63 offen nt
  buffer_load_dwordx4 a[108:111], v254, s[48:51], s63 offen nt
  s_add_u32 s63, s63, 73728
  buffer_load_dwordx4 a[40:43], v254, s[44:47], s63 offen nt
  buffer_load_dwordx4 a[112:115], v254, s[48:51], s63 offen nt
  s_add_u32 s63, s63, 73728
  buffer_load_dwordx4 a[44:47], v254, s[44:47], s63 offen nt
  buffer_load_dwordx4 a[116:119], v254, s[48:51], s63 offen nt
  s_add_u32 s63, s63, 73728
  buffer_load_dwordx4 a[48:51], v254, s[44:47], s63 offen nt
  buffer_load_dwordx4 a[120:123], v254, s[48:51], s63 offen nt
  s_add_u32 s63, s63, 73728
  buffer_load_dwordx4 a[52:55], v254, s[44:47], s63 offen nt
  buffer_load_dwordx4 a[124:127], v254, s[48:51], s63 offen nt
  s_add_u32 s63, s63, 73728
  buffer_load_dwordx4 a[56:59], v254, s[44:47], s63 offen nt
  buffer_load_dwordx4 a[128:131], v254, s[48:51], s63 offen nt
  s_add_u32 s63, s63, 73728
  buffer_load_dwordx4 a[60:63], v254, s[44:47], s63 offen nt
  buffer_load_dwordx4 a[132:135], v254, s[48:51], s63 offen nt
  s_add_u32 s63, s63, 73728
  buffer_load_dwordx4 a[64:67], v254, s[44:47], s63 offen nt
  buffer_load_dwordx4 a[136:139], v254, s[48:51], s63 offen nt
  s_add_u32 s63, s63, 73728
  buffer_load_dwordx4 a[68:71], v254, s[44:47], s63 offen nt
  buffer_load_dwordx4 a[140:143], v254, s[48:51], s63 offen nt
  buffer_load_dwordx4 v[224:227], v92, s[40:43], s72 offen sc1
  buffer_load_dwordx4 v[228:231], v92, s[40:43], s72 offen offset:16 sc1
  buffer_load_dwordx4 v[128:131], v2, s[32:35], s52 offen offset:0 nt
  buffer_load_dwordx4 v[132:135], v2, s[32:35], s52 offen offset:64 nt
  buffer_load_dwordx4 v[136:139], v2, s[32:35], s52 offen offset:128 nt
  buffer_load_dwordx4 v[140:143], v2, s[32:35], s52 offen offset:192 nt
  buffer_load_dwordx4 v[144:147], v3, s[36:39], s52 offen offset:0 nt
  buffer_load_dwordx4 v[148:151], v3, s[36:39], s52 offen offset:256 nt
  buffer_load_dwordx4 v[152:155], v3, s[36:39], s52 offen offset:512 nt
  buffer_load_dwordx4 v[156:159], v3, s[36:39], s52 offen offset:768 nt
  s_add_u32 s52, s52, 16384
  v_sub_f32 v192, v192, v210
  v_cvt_pk_bf16_f32 v192, v192, v192
  v_and_b32 v192, 0xffff0000, v192
  v_mul_f32 v213, v192, v212
  v_fma_f32 v214, -v213, v211, v192
  v_fma_f32 v213, v214, v212, v213
  v_cvt_pk_bf16_f32 v192, v213, v213
  v_sub_f32 v193, v193, v210
  v_cvt_pk_bf16_f32 v193, v193, v193
  v_and_b32 v193, 0xffff0000, v193
  v_mul_f32 v213, v193, v212
  v_fma_f32 v214, -v213, v211, v193
  v_fma_f32 v213, v214, v212, v213
  v_cvt_pk_bf16_f32 v193, v213, v213
  v_sub_f32 v194, v194, v210
  v_cvt_pk_bf16_f32 v194, v194, v194
  v_and_b32 v194, 0xffff0000, v194
  v_mul_f32 v213, v194, v212
  v_fma_f32 v214, -v213, v211, v194
  v_fma_f32 v213, v214, v212, v213
  v_cvt_pk_bf16_f32 v194, v213, v213
  v_sub_f32 v195, v195, v210
  v_cvt_pk_bf16_f32 v195, v195, v195
  v_and_b32 v195, 0xffff0000, v195
  v_mul_f32 v213, v195, v212
  v_fma_f32 v214, -v213, v211, v195
  v_fma_f32 v213, v214, v212, v213
  v_cvt_pk_bf16_f32 v195, v213, v213
  v_sub_f32 v196, v196, v210
  v_cvt_pk_bf16_f32 v196, v196, v196
  v_and_b32 v196, 0xffff0000, v196
  v_mul_f32 v213, v196, v212
  v_fma_f32 v214, -v213, v211, v196
  v_fma_f32 v213, v214, v212, v213
  v_cvt_pk_bf16_f32 v196, v213, v213
  v_sub_f32 v197, v197, v210
  v_cvt_pk_bf16_f32 v197, v197, v197
  v_and_b32 v197, 0xffff0000, v197
  v_mul_f32 v213, v197, v212
  v_fma_f32 v214, -v213, v211, v197
  v_fma_f32 v213, v214, v212, v213
  v_cvt_pk_bf16_f32 v197, v213, v213
  v_sub_f32 v198, v198, v210
  v_cvt_pk_bf16_f32 v198, v198, v198
  v_and_b32 v198, 0xffff0000, v198
  v_mul_f32 v213, v198, v212
  v_fma_f32 v214, -v213, v211, v198
  v_fma_f32 v213, v214, v212, v213
  v_cvt_pk_bf16_f32 v198, v213, v213
  v_sub_f32 v199, v199, v210
  v_cvt_pk_bf16_f32 v199, v199, v199
  v_and_b32 v199, 0xffff0000, v199
  v_mul_f32 v213, v199, v212
  v_fma_f32 v214, -v213, v211, v199
  v_fma_f32 v213, v214, v212, v213
  v_cvt_pk_bf16_f32 v199, v213, v213
  v_sub_f32 v200, v200, v210
  v_cvt_pk_bf16_f32 v200, v200, v200
  v_and_b32 v200, 0xffff0000, v200
  v_mul_f32 v213, v200, v212
  v_fma_f32 v214, -v213, v211, v200
  v_fma_f32 v213, v214, v212, v213
  v_cvt_pk_bf16_f32 v200, v213, v213
  v_sub_f32 v201, v201, v210
  v_cvt_pk_bf16_f32 v201, v201, v201
  v_and_b32 v201, 0xffff0000, v201
  v_mul_f32 v213, v201, v212
  v_fma_f32 v214, -v213, v211, v201
  v_fma_f32 v213, v214, v212, v213
  v_cvt_pk_bf16_f32 v201, v213, v213
  v_sub_f32 v202, v202, v210
  v_cvt_pk_bf16_f32 v202, v202, v202
  v_and_b32 v202, 0xffff0000, v202
  v_mul_f32 v213, v202, v212
  v_fma_f32 v214, -v213, v211, v202
  v_fma_f32 v213, v214, v212, v213
  v_cvt_pk_bf16_f32 v202, v213, v213
  v_sub_f32 v203, v203, v210
  v_cvt_pk_bf16_f32 v203, v203, v203
  v_and_b32 v203, 0xffff0000, v203
  v_mul_f32 v213, v203, v212
  v_fma_f32 v214, -v213, v211, v203
  v_fma_f32 v213, v214, v212, v213
  v_cvt_pk_bf16_f32 v203, v213, v213
  v_sub_f32 v204, v204, v210
  v_cvt_pk_bf16_f32 v204, v204, v204
  v_and_b32 v204, 0xffff0000, v204
  v_mul_f32 v213, v204, v212
  v_fma_f32 v214, -v213, v211, v204
  v_fma_f32 v213, v214, v212, v213
  v_cvt_pk_bf16_f32 v204, v213, v213
  v_sub_f32 v205, v205, v210
  v_cvt_pk_bf16_f32 v205, v205, v205
  v_and_b32 v205, 0xffff0000, v205
  v_mul_f32 v213, v205, v212
  v_fma_f32 v214, -v213, v211, v205
  v_fma_f32 v213, v214, v212, v213
  v_cvt_pk_bf16_f32 v205, v213, v213
  v_sub_f32 v206, v206, v210
  v_cvt_pk_bf16_f32 v206, v206, v206
  v_and_b32 v206, 0xffff0000, v206
  v_mul_f32 v213, v206, v212
  v_fma_f32 v214, -v213, v211, v206
  v_fma_f32 v213, v214, v212, v213
  v_cvt_pk_bf16_f32 v206, v213, v213
  v_sub_f32 v207, v207, v210
  v_cvt_pk_bf16_f32 v207, v207, v207
  v_and_b32 v207, 0xffff0000, v207
  v_mul_f32 v213, v207, v212
  v_fma_f32 v214, -v213, v211, v207
  v_fma_f32 v213, v214, v212, v213
  v_cvt_pk_bf16_f32 v207, v213, v213
  v_lshlrev_b32 v215, 5, v0
  ds_write_b128 v215, v[192:195] offset:0
  ds_write_b128 v215, v[196:199] offset:16
  s_mov_b32 exec_lo, 0xff
  s_mov_b32 exec_hi, 0
  ds_write_b128 v215, v[200:203] offset:2048
  ds_write_b128 v215, v[204:207] offset:2064
  s_mov_b64 exec, -1
  s_mul_i32 s63, s5, 576
  v_add_u32 v255, s63, v255
  ds_read_b32 v192, v255 offset:0
  ds_read_b32 v193, v255 offset:32
  ds_read_b32 v194, v255 offset:64
  ds_read_b32 v195, v255 offset:96
  ds_read_b32 v196, v255 offset:128
  ds_read_b32 v197, v255 offset:160
  ds_read_b32 v198, v255 offset:192
  ds_read_b32 v199, v255 offset:224
  ds_read_b32 v200, v255 offset:256
  ds_read_b32 v201, v255 offset:288
  ds_read_b32 v202, v255 offset:320
  ds_read_b32 v203, v255 offset:352
  ds_read_b32 v204, v255 offset:384
  ds_read_b32 v205, v255 offset:416
  ds_read_b32 v206, v255 offset:448
  ds_read_b32 v207, v255 offset:480
  ds_read_b32 v208, v255 offset:512
  ds_read_b32 v209, v255 offset:544
  s_waitcnt lgkmcnt(0)
  s_waitcnt vmcnt(10)
  v_and_b32 v48, v192, v4
  v_and_b32 v49, v192, v5
  v_and_b32 v50, v192, v6
  v_and_b32 v51, v192, v7
  s_nop 1
  v_mfma_f32_16x16x32_bf16 v[212:215], v[48:51], a[0:3], 0
  v_mfma_f32_16x16x32_bf16 v[216:219], v[48:51], a[72:75], 0
  v_and_b32 v52, v193, v4
  v_and_b32 v53, v193, v5
  v_and_b32 v54, v193, v6
  v_and_b32 v55, v193, v7
  s_nop 1
  v_mfma_f32_16x16x32_bf16 v[212:215], v[52:55], a[4:7], v[212:215]
  v_mfma_f32_16x16x32_bf16 v[216:219], v[52:55], a[76:79], v[216:219]
  v_and_b32 v48, v194, v4
  v_and_b32 v49, v194, v5
  v_and_b32 v50, v194, v6
  v_and_b32 v51, v194, v7
  s_nop 1
  v_mfma_f32_16x16x32_bf16 v[212:215], v[48:51], a[8:11], v[212:215]
  v_mfma_f32_16x16x32_bf16 v[216:219], v[48:51], a[80:83], v[216:219]
  v_and_b32 v52, v195, v4
  v_and_b32 v53, v195, v5
  v_and_b32 v54, v195, v6
  v_and_b32 v55, v195, v7
  s_nop 1
  v_mfma_f32_16x16x32_bf16 v[212:215], v[52:55], a[12:15], v[212:215]
  v_mfma_f32_16x16x32_bf16 v[216:219], v[52:55], a[84:87], v[216:219]
  v_and_b32 v48, v196, v4
  v_and_b32 v49, v196, v5
  v_and_b32 v50, v196, v6
  v_and_b32 v51, v196, v7
  s_nop 1
  v_mfma_f32_16x16x32_bf16 v[212:215], v[48:51], a[16:19], v[212:215]
  v_mfma_f32_16x16x32_bf16 v[216:219], v[48:51], a[88:91], v[216:219]
  v_and_b32 v52, v197, v4
  v_and_b32 v53, v197, v5
  v_and_b32 v54, v197, v6
  v_and_b32 v55, v197, v7
  s_nop 1
  v_mfma_f32_16x16x32_bf16 v[212:215], v[52:55], a[20:23], v[212:215]
  v_mfma_f32_16x16x32_bf16 v[216:219], v[52:55], a[92:95], v[216:219]
  v_and_b32 v48, v198, v4
  v_and_b32 v49, v198, v5
  v_and_b32 v50, v198, v6
  v_and_b32 v51, v198, v7
  s_nop 1
  v_mfma_f32_16x16x32_bf16 v[212:215], v[48:51], a[24:27], v[212:215]
  v_mfma_f32_16x16x32_bf16 v[216:219], v[48:51], a[96:99], v[216:219]
  v_and_b32 v52, v199, v4
  v_and_b32 v53, v199, v5
  v_and_b32 v54, v199, v6
  v_and_b32 v55, v199, v7
  s_nop 1
  v_mfma_f32_16x16x32_bf16 v[212:215], v[52:55], a[28:31], v[212:215]
  v_mfma_f32_16x16x32_bf16 v[216:219], v[52:55], a[100:103], v[216:219]
  v_and_b32 v48, v200, v4
  v_and_b32 v49, v200, v5
  v_and_b32 v50, v200, v6
  v_and_b32 v51, v200, v7
  s_nop 1
  v_mfma_f32_16x16x32_bf16 v[212:215], v[48:51], a[32:35], v[212:215]
  v_mfma_f32_16x16x32_bf16 v[216:219], v[48:51], a[104:107], v[216:219]
  v_and_b32 v52, v201, v4
  v_and_b32 v53, v201, v5
  v_and_b32 v54, v201, v6
  v_and_b32 v55, v201, v7
  s_nop 1
  v_mfma_f32_16x16x32_bf16 v[212:215], v[52:55], a[36:39], v[212:215]
  v_mfma_f32_16x16x32_bf16 v[216:219], v[52:55], a[108:111], v[216:219]
  v_and_b32 v48, v202, v4
  v_and_b32 v49, v202, v5
  v_and_b32 v50, v202, v6
  v_and_b32 v51, v202, v7
  s_nop 1
  v_mfma_f32_16x16x32_bf16 v[212:215], v[48:51], a[40:43], v[212:215]
  v_mfma_f32_16x16x32_bf16 v[216:219], v[48:51], a[112:115], v[216:219]
  v_and_b32 v52, v203, v4
  v_and_b32 v53, v203, v5
  v_and_b32 v54, v203, v6
  v_and_b32 v55, v203, v7
  s_nop 1
  v_mfma_f32_16x16x32_bf16 v[212:215], v[52:55], a[44:47], v[212:215]
  v_mfma_f32_16x16x32_bf16 v[216:219], v[52:55], a[116:119], v[216:219]
  v_and_b32 v48, v204, v4
  v_and_b32 v49, v204, v5
  v_and_b32 v50, v204, v6
  v_and_b32 v51, v204, v7
  s_nop 1
  v_mfma_f32_16x16x32_bf16 v[212:215], v[48:51], a[48:51], v[212:215]
  v_mfma_f32_16x16x32_bf16 v[216:219], v[48:51], a[120:123], v[216:219]
  v_and_b32 v52, v205, v4
  v_and_b32 v53, v205, v5
  v_and_b32 v54, v205, v6
  v_and_b32 v55, v205, v7
  s_nop 1
  v_mfma_f32_16x16x32_bf16 v[212:215], v[52:55], a[52:55], v[212:215]
  v_mfma_f32_16x16x32_bf16 v[216:219], v[52:55], a[124:127], v[216:219]
  v_and_b32 v48, v206, v4
  v_and_b32 v49, v206, v5
  v_and_b32 v50, v206, v6
  v_and_b32 v51, v206, v7
  s_nop 1
  v_mfma_f32_16x16x32_bf16 v[212:215], v[48:51], a[56:59], v[212:215]
  v_mfma_f32_16x16x32_bf16 v[216:219], v[48:51], a[128:131], v[216:219]
  v_and_b32 v52, v207, v4
  v_and_b32 v53, v207, v5
  v_and_b32 v54, v207, v6
  v_and_b32 v55, v207, v7
  s_nop 1
  v_mfma_f32_16x16x32_bf16 v[212:215], v[52:55], a[60:63], v[212:215]
  v_mfma_f32_16x16x32_bf16 v[216:219], v[52:55], a[132:135], v[216:219]
  v_and_b32 v48, v208, v4
  v_and_b32 v49, v208, v5
  v_and_b32 v50, v208, v6
  v_and_b32 v51, v208, v7
  s_nop 1
  v_mfma_f32_16x16x32_bf16 v[212:215], v[48:51], a[64:67], v[212:215]
  v_mfma_f32_16x16x32_bf16 v[216:219], v[48:51], a[136:139], v[216:219]
  v_and_b32 v52, v209, v4
  v_and_b32 v53, v209, v5
  v_and_b32 v54, v209, v6
  v_and_b32 v55, v209, v7
  s_nop 1
  v_mfma_f32_16x16x32_bf16 v[212:215], v[52:55], a[68:71], v[212:215]
  v_mfma_f32_16x16x32_bf16 v[216:219], v[52:55], a[140:143], v[216:219]
  s_waitcnt vmcnt(8)
  s_mov_b32 s55, 400000
L_qb_chk:
  v_xor_b32 v94, s76, v225
  v_xor_b32 v95, s77, v227
  v_or_b32 v94, v94, v95
  v_xor_b32 v95, s76, v229
  v_or_b32 v94, v94, v95
  v_xor_b32 v95, s77, v231
  v_or_b32 v94, v94, v95
  v_cmp_ne_u32 vcc, 0, v94
  s_cbranch_vccz L_qb_ok
  s_sub_u32 s55, s55, 1
  s_cmp_eq_u32 s55, 0
  s_cbranch_scc1 parallel_sum__gqa_block_cached__glu_gated_geglu__decode_kernel_end
  buffer_load_dwordx4 v[224:227], v92, s[40:43], s72 offen sc1
  buffer_load_dwordx4 v[228:231], v92, s[40:43], s72 offen offset:16 sc1
  s_waitcnt vmcnt(0)
  s_branch L_qb_chk
L_qb_ok:
  s_mul_i32 s64, s54, 1152
  s_add_u32 s48, s24, s64
  s_addc_u32 s49, s25, 0
  s_cmp_eq_u32 s60, 1
  s_mov_b32 s50, 73728
  s_cselect_b32 s50, 36864, s50
  s_mov_b32 s51, 0x20000
  s_mul_i32 s63, s5, 18432
  buffer_load_dwordx4 a[144:147], v251, s[48:51], s63 offen offset:0 nt
  buffer_load_dwordx4 a[148:151], v251, s[48:51], s63 offen offset:256 nt
  buffer_load_dwordx4 a[152:155], v251, s[48:51], s63 offen offset:512 nt
  buffer_load_dwordx4 a[156:159], v251, s[48:51], s63 offen offset:768 nt
  buffer_load_dwordx4 a[160:163], v252, s[48:51], s63 offen offset:1024 nt
  s_add_u32 s63, s63, 4608
  buffer_load_dwordx4 a[164:167], v251, s[48:51], s63 offen offset:0 nt
  buffer_load_dwordx4 a[168:171], v251, s[48:51], s63 offen offset:256 nt
  buffer_load_dwordx4 a[172:175], v251, s[48:51], s63 offen offset:512 nt
  buffer_load_dwordx4 a[176:179], v251, s[48:51], s63 offen offset:768 nt
  buffer_load_dwordx4 a[180:183], v252, s[48:51], s63 offen offset:1024 nt
  s_add_u32 s63, s63, 4608
  buffer_load_dwordx4 a[184:187], v251, s[48:51], s63 offen offset:0 nt
  buffer_load_dwordx4 a[188:191], v251, s[48:51], s63 offen offset:256 nt
  buffer_load_dwordx4 a[192:195], v251, s[48:51], s63 offen offset:512 nt
  buffer_load_dwordx4 a[196:199], v251, s[48:51], s63 offen offset:768 nt
  buffer_load_dwordx4 a[200:203], v252, s[48:51], s63 offen offset:1024 nt
  s_add_u32 s63, s63, 4608
  buffer_load_dwordx4 a[204:207], v251, s[48:51], s63 offen offset:0 nt
  buffer_load_dwordx4 a[208:211], v251, s[48:51], s63 offen offset:256 nt
  buffer_load_dwordx4 a[212:215], v251, s[48:51], s63 offen offset:512 nt
  buffer_load_dwordx4 a[216:219], v251, s[48:51], s63 offen offset:768 nt
  buffer_load_dwordx4 a[220:223], v252, s[48:51], s63 offen offset:1024 nt
  v_and_b32 v88, 7, v0
  v_lshlrev_b32 v88, 5, v88
  v_bfe_u32 v89, v0, 4, 1
  v_lshl_add_u32 v88, v89, 4, v88
  v_bfe_u32 v89, v0, 3, 1
  v_lshl_add_u32 v88, v89, 8, v88
  s_lshl_b32 s63, s5, 9
  v_add_u32 v88, s63, v88
  s_mov_b32 exec_lo, 0x00ff00ff
  s_mov_b32 exec_hi, 0xff00ff00
  ds_write_b128 v88, v[212:215] offset:10752
  ds_write_b128 v88, v[216:219] offset:12800
  s_mov_b64 exec, -1
  s_waitcnt lgkmcnt(0)
  s_barrier
  v_lshlrev_b32 v88, 2, v0
  ds_read_b32 v192, v88 offset:10752
  ds_read_b32 v200, v88 offset:12800
  ds_read_b32 v193, v88 offset:11008
  ds_read_b32 v201, v88 offset:13056
  ds_read_b32 v194, v88 offset:11264
  ds_read_b32 v202, v88 offset:13312
  ds_read_b32 v195, v88 offset:11520
  ds_read_b32 v203, v88 offset:13568
  ds_read_b32 v196, v88 offset:11776
  ds_read_b32 v204, v88 offset:13824
  ds_read_b32 v197, v88 offset:12032
  ds_read_b32 v205, v88 offset:14080
  ds_read_b32 v198, v88 offset:12288
  ds_read_b32 v206, v88 offset:14336
  ds_read_b32 v199, v88 offset:12544
  ds_read_b32 v207, v88 offset:14592
  s_waitcnt lgkmcnt(0)
  v_add_f32 v192, v192, v196
  v_add_f32 v193, v193, v197
  v_add_f32 v194, v194, v198
  v_add_f32 v195, v195, v199
  v_add_f32 v192, v192, v193
  v_add_f32 v194, v194, v195
  v_add_f32 v192, v192, v194
  v_cvt_pk_bf16_f32 v192, v192, v192
  v_and_b32 v192, 0xffff0000, v192
  v_add_f32 v200, v200, v204
  v_add_f32 v201, v201, v205
  v_add_f32 v202, v202, v206
  v_add_f32 v203, v203, v207
  v_add_f32 v200, v200, v201
  v_add_f32 v202, v202, v203
  v_add_f32 v200, v200, v202
  v_cvt_pk_bf16_f32 v200, v200, v200
  v_and_b32 v200, 0xffff0000, v200
  v_mul_f32 v193, v192, v192
  v_mov_b32 v194, 1.0
  v_fmac_f32 v194, 0x3d372713, v193
  v_mul_f32 v194, v194, v192
  v_mul_f32 v194, 0xc0135761, v194
  v_exp_f32 v194, v194
  s_nop 0
  v_add_f32 v194, 1.0, v194
  v_rcp_f32 v194, v194
  s_nop 0
  v_mul_f32 v194, v194, v192
  v_cvt_pk_bf16_f32 v194, v194, v194
  v_and_b32 v194, 0xffff0000, v194
  v_mul_f32 v194, v194, v200
  v_cvt_pk_bf16_f32 v194, v194, v194
  s_lshl_b32 s63, s5, 8
  v_add_u32 v88, s63, v88
  ds_write_b32 v88, v194 offset:14848
  v_mov_b32 v225, v226
  v_mov_b32 v226, v228
  v_mov_b32 v227, v230
  v_lshlrev_b32 v94, 4, v1
  ds_write_b128 v94, v[224:227] offset:4608
  s_waitcnt lgkmcnt(0)
  s_barrier
  v_lshlrev_b32 v94, 4, v0
  ds_read_b128 v[224:227], v94 offset:4608
  ds_read_b128 v[228:231], v94 offset:5632
  ds_read_b128 v[232:235], v94 offset:6656
  ds_read_b128 v[236:239], v94 offset:7680
  s_lshl_b32 s63, s5, 9
  v_lshlrev_b32 v95, 3, v0
  v_add_u32 v95, s63, v95
  s_waitcnt lgkmcnt(0)
  v_pk_add_f32 v[224:225], v[224:225], v[228:229]
  v_pk_add_f32 v[232:233], v[232:233], v[236:237]
  v_pk_add_f32 v[226:227], v[226:227], v[230:231]
  v_pk_add_f32 v[234:235], v[234:235], v[238:239]
  v_pk_add_f32 v[224:225], v[224:225], v[232:233]
  v_pk_add_f32 v[226:227], v[226:227], v[234:235]
  v_cvt_pk_bf16_f32 v224, v224, v225
  v_cvt_pk_bf16_f32 v225, v226, v227
  ds_write_b64 v95, v[224:225] offset:8704
  v_bfe_u32 v94, v0, 3, 1
  v_lshlrev_b32 v94, 8, v94
  v_lshrrev_b32 v95, 4, v0
  v_lshl_add_u32 v94, v95, 4, v94
  v_add_u32 v94, s63, v94
  ds_read_b128 v[8:11], v94 offset:8704
  ds_read_b128 v[12:15], v94 offset:8768
  ds_read_b128 v[16:19], v94 offset:8832
  ds_read_b128 v[20:23], v94 offset:8896
  s_waitcnt lgkmcnt(0)
L_preloop:
  v_lshrrev_b32 v224, 5, v0
  v_lshlrev_b32 v224, 7, v224
  v_and_b32 v225, 15, v0
  v_lshl_add_u32 v224, v225, 3, v224
  v_bfe_u32 v226, v0, 4, 1
  v_lshl_add_u32 v224, v226, 2, v224
  v_lshlrev_b32 v224, 2, v224
  s_lshl_b32 s63, s5, 10
  v_add_u32 v192, s63, v224
  v_bfe_u32 v224, v0, 3, 1
  v_lshlrev_b32 v224, 5, v224
  s_lshl_b32 s63, s5, 3
  v_add_u32 v193, s63, v224
  v_lshlrev_b32 v194, 2, v1
  v_lshrrev_b32 v224, 7, v1
  v_lshlrev_b32 v195, 5, v224
  s_lshl_b32 s63, s2, 7
  s_add_u32 s63, s63, 196608
  v_lshl_add_u32 v224, v224, 4, s63
  v_lshrrev_b32 v225, 4, v1
  v_lshlrev_b32 v225, 11, v225
  s_lshl_b32 s63, s3, 15
  s_lshl_b32 s64, s4, 7
  s_add_u32 s63, s63, s64
  s_add_u32 s63, s63, 262144
  v_add_u32 v225, s63, v225
  v_and_b32 v226, 15, v1
  v_lshl_add_u32 v225, v226, 3, v225
  v_and_b32 v226, 127, v1
  v_cmp_eq_u32 s[68:69], 1, v226
  v_and_b32 v226, 1, v1
  v_cmp_eq_u32 vcc, 0, v226
  v_mov_b32 v196, 0x7fff0000
  s_mov_b32 s70, 0xffff0000
  s_mov_b32 s71, 0xffff0000
  v_cndmask_b32 v196, v196, v225, vcc
  v_cndmask_b32 v196, v196, v224, s[68:69]
  v_and_b32 v224, 15, v0
  v_lshrrev_b32 v225, 5, v0
  v_lshlrev_b32 v225, 4, v225
  v_lshl_add_u32 v225, v224, 7, v225
  s_lshl_b32 s63, s2, 11
  s_add_u32 s63, s63, 262144
  s_lshl_b32 s64, s5, 5
  s_add_u32 s63, s63, s64
  v_add_u32 v197, s63, v225
  s_lshl_b32 s63, s3, 11
  s_lshr_b32 s64, s4, 3
  s_lshl_b32 s64, s64, 4
  s_add_u32 s63, s63, s64
  s_add_u32 s63, s63, 196608
  v_lshlrev_b32 v224, 7, v224
  v_add_u32 v198, s63, v224
  v_and_b32 v224, 15, v0
  v_lshlrev_b32 v224, 5, v224
  v_bfe_u32 v225, v0, 4, 1
  v_lshl_add_u32 v224, v225, 4, v224
  s_mul_i32 s63, s5, 2304
  v_add_u32 v199, s63, v224
  s_mul_i32 s63, s5, 40
  s_cmp_eq_u32 s5, 3
  s_cselect_b32 s63, 112, s63
  s_cmp_lt_u32 s5, 2
  s_cselect_b32 s64, 40, 32
  v_add_u32 v224, s63, v0
  v_min_u32 v225, 143, v224
  v_lshlrev_b32 v200, 4, v225
  v_lshrrev_b32 v226, 3, v224
  v_lshlrev_b32 v226, 15, v226
  v_and_b32 v202, 7, v224
  v_lshl_add_u32 v202, v202, 4, v226
  s_lshl_b32 s63, s2, 7
  s_add_u32 s63, s63, 786432
  v_add_u32 v202, s63, v202
  v_cmp_gt_u32 vcc, s64, v0
  v_mov_b32 v226, 0x7fff0000
  v_mov_b32 v203, 0xfffff000
  v_cndmask_b32 v202, v226, v202, vcc
  s_and_b32 s20, s76, 0xfff
  s_bfe_u32 s21, s76, 0xc000c
  s_and_b32 s22, s77, 0xfff
  s_bfe_u32 s23, s77, 0xc000c
  v_lshrrev_b32 v208, 4, v0
  v_lshlrev_b32 v208, 2, v208
  s_mul_i32 s63, s5, 320
  v_add_u32 v208, s63, v208
  v_lshlrev_b32 v204, 4, v1
  s_lshl_b32 s63, s2, 15
  s_add_u32 s63, s63, 786432
  v_add_u32 v204, s63, v204
  s_mul_i32 s63, s2, 64
  v_lshlrev_b32 v205, 1, v0
  v_add_u32 v205, s63, v205
  v_lshlrev_b32 v206, 4, v0
  s_mul_i32 s63, s5, 128
  v_add_u32 v206, s63, v206
  v_and_b32 v207, 31, v0
  v_lshlrev_b32 v207, 2, v207
  v_mov_b32 v213, s76
  v_mov_b32 v215, s77
  v_mov_b32 v217, s76
  v_mov_b32 v219, s77
  v_mov_b32 v221, s76
  v_mov_b32 v223, s77
  s_mov_b32 s44, s8
  s_mov_b32 s45, s9
  s_mov_b32 s46, 1152
  s_mov_b32 s47, 0x20000
  s_mov_b32 s48, s26
  s_mov_b32 s49, s27
  s_mov_b32 s50, 1152
  s_mov_b32 s51, 0x20000
  buffer_load_ushort v209, v205, s[44:47], 0 offen
  s_mov_b32 s72, s16
  s_mov_b32 s73, s17
  s_mov_b32 s74, 4718592
  s_mov_b32 s75, 0x20000
  s_lshl_b32 s63, s2, 4
  s_lshl_b32 s64, s5, 2
  s_add_u32 s63, s63, s64
  s_mul_i32 s61, s63, 1152
  s_mov_b64 s[66:67], -1
  s_add_u32 s10, s6, 57
  s_sub_u32 s11, 1020, s10
  s_add_u32 s19, s10, s7
  s_sub_u32 s12, 1276, s19
  s_add_u32 s13, s19, -92
  s_mov_b32 s18, 0
.p2align 6
L_loop:
  s_waitcnt vmcnt(12)
  v_mfma_f32_16x16x32_bf16 v[32:35], v[96:99], v[8:11], 0
  v_mfma_f32_16x16x32_bf16 v[32:35], v[100:103], v[12:15], v[32:35]
  v_mfma_f32_16x16x32_bf16 v[32:35], v[104:107], v[16:19], v[32:35]
  v_mfma_f32_16x16x32_bf16 v[32:35], v[108:111], v[20:23], v[32:35]
  s_mov_b64 exec, s[66:67]
  buffer_load_dwordx4 v[96:99], v2, s[32:35], s52 offen offset:0 nt
  buffer_load_dwordx4 v[100:103], v2, s[32:35], s52 offen offset:64 nt
  buffer_load_dwordx4 v[104:107], v2, s[32:35], s52 offen offset:128 nt
  buffer_load_dwordx4 v[108:111], v2, s[32:35], s52 offen offset:192 nt
  s_mov_b64 exec, -1
  s_nop 1
  v_cvt_pk_bf16_f32 v40, v32, v33
  v_cvt_pk_bf16_f32 v41, v34, v35
  v_lshlrev_b32 v36, 16, v40
  v_and_b32 v37, 0xffff0000, v40
  v_lshlrev_b32 v38, 16, v41
  v_and_b32 v39, 0xffff0000, v41
  v_pk_mul_f32 v[36:37], v[36:37], s[56:57]
  v_pk_mul_f32 v[38:39], v[38:39], s[56:57]
  v_cvt_pk_bf16_f32 v40, v36, v37
  v_cvt_pk_bf16_f32 v41, v38, v39
  v_lshlrev_b32 v36, 16, v40
  v_and_b32 v37, 0xffff0000, v40
  v_lshlrev_b32 v38, 16, v41
  v_and_b32 v39, 0xffff0000, v41
  v_max3_f32 v46, v36, v37, v38
  v_max_f32 v46, v46, v39
  v_cmp_gt_f32 vcc, v46, v28
  s_cbranch_vccnz L_slow0
L_back0:
  v_fma_f32 v42, v36, s58, -v29
  v_fma_f32 v43, v37, s58, -v29
  v_fma_f32 v44, v38, s58, -v29
  v_fma_f32 v45, v39, s58, -v29
  v_exp_f32 v42, v42
  v_exp_f32 v43, v43
  v_exp_f32 v44, v44
  v_exp_f32 v45, v45
  v_cvt_pk_bf16_f32 v76, v42, v42
  v_cvt_pk_bf16_f32 v77, v43, v43
  v_cvt_pk_bf16_f32 v78, v44, v44
  v_cvt_pk_bf16_f32 v79, v45, v45
  v_add_f32 v40, v42, v43
  v_add_f32 v41, v44, v45
  v_add_f32 v30, v30, v40
  v_add_f32 v30, v30, v41
  v_and_b32 v48, v76, v4
  v_and_b32 v49, v76, v5
  v_and_b32 v50, v76, v6
  v_and_b32 v51, v76, v7
  v_and_b32 v52, v77, v4
  v_and_b32 v53, v77, v5
  v_and_b32 v54, v77, v6
  v_and_b32 v55, v77, v7
  s_waitcnt vmcnt(12)
  v_mfma_f32_16x16x32_bf16 v[24:27], v[48:51], v[112:115], v[24:27]
  v_and_b32 v48, v78, v4
  v_and_b32 v49, v78, v5
  v_and_b32 v50, v78, v6
  v_and_b32 v51, v78, v7
  v_mfma_f32_16x16x32_bf16 v[24:27], v[52:55], v[116:119], v[24:27]
  v_and_b32 v52, v79, v4
  v_and_b32 v53, v79, v5
  v_and_b32 v54, v79, v6
  v_and_b32 v55, v79, v7
  v_mfma_f32_16x16x32_bf16 v[24:27], v[48:51], v[120:123], v[24:27]
  s_nop 0
  v_mfma_f32_16x16x32_bf16 v[24:27], v[52:55], v[124:127], v[24:27]
  s_mov_b64 exec, s[66:67]
  buffer_load_dwordx4 v[112:115], v3, s[36:39], s52 offen offset:0 nt
  buffer_load_dwordx4 v[116:119], v3, s[36:39], s52 offen offset:256 nt
  buffer_load_dwordx4 v[120:123], v3, s[36:39], s52 offen offset:512 nt
  buffer_load_dwordx4 v[124:127], v3, s[36:39], s52 offen offset:768 nt
  s_add_u32 s52, s52, 16384
  s_mov_b64 exec, -1
  s_sub_u32 s53, s53, 1
  s_cmp_le_u32 s53, 7
  s_cbranch_scc1 L_near0
L_cont0:
  s_waitcnt vmcnt(12)
  v_mfma_f32_16x16x32_bf16 v[32:35], v[128:131], v[8:11], 0
  v_mfma_f32_16x16x32_bf16 v[32:35], v[132:135], v[12:15], v[32:35]
  v_mfma_f32_16x16x32_bf16 v[32:35], v[136:139], v[16:19], v[32:35]
  v_mfma_f32_16x16x32_bf16 v[32:35], v[140:143], v[20:23], v[32:35]
  s_mov_b64 exec, s[66:67]
  buffer_load_dwordx4 v[128:131], v2, s[32:35], s52 offen offset:0 nt
  buffer_load_dwordx4 v[132:135], v2, s[32:35], s52 offen offset:64 nt
  buffer_load_dwordx4 v[136:139], v2, s[32:35], s52 offen offset:128 nt
  buffer_load_dwordx4 v[140:143], v2, s[32:35], s52 offen offset:192 nt
  s_mov_b64 exec, -1
  s_nop 1
  v_cvt_pk_bf16_f32 v40, v32, v33
  v_cvt_pk_bf16_f32 v41, v34, v35
  v_lshlrev_b32 v36, 16, v40
  v_and_b32 v37, 0xffff0000, v40
  v_lshlrev_b32 v38, 16, v41
  v_and_b32 v39, 0xffff0000, v41
  v_pk_mul_f32 v[36:37], v[36:37], s[56:57]
  v_pk_mul_f32 v[38:39], v[38:39], s[56:57]
  v_cvt_pk_bf16_f32 v40, v36, v37
  v_cvt_pk_bf16_f32 v41, v38, v39
  v_lshlrev_b32 v36, 16, v40
  v_and_b32 v37, 0xffff0000, v40
  v_lshlrev_b32 v38, 16, v41
  v_and_b32 v39, 0xffff0000, v41
  v_max3_f32 v46, v36, v37, v38
  v_max_f32 v46, v46, v39
  v_cmp_gt_f32 vcc, v46, v28
  s_cbranch_vccnz L_slow1
L_back1:
  v_fma_f32 v42, v36, s58, -v29
  v_fma_f32 v43, v37, s58, -v29
  v_fma_f32 v44, v38, s58, -v29
  v_fma_f32 v45, v39, s58, -v29
  v_exp_f32 v42, v42
  v_exp_f32 v43, v43
  v_exp_f32 v44, v44
  v_exp_f32 v45, v45
  v_cvt_pk_bf16_f32 v76, v42, v42
  v_cvt_pk_bf16_f32 v77, v43, v43
  v_cvt_pk_bf16_f32 v78, v44, v44
  v_cvt_pk_bf16_f32 v79, v45, v45
  v_add_f32 v40, v42, v43
  v_add_f32 v41, v44, v45
  v_add_f32 v30, v30, v40
  v_add_f32 v30, v30, v41
  v_and_b32 v48, v76, v4
  v_and_b32 v49, v76, v5
  v_and_b32 v50, v76, v6
  v_and_b32 v51, v76, v7
  v_and_b32 v52, v77, v4
  v_and_b32 v53, v77, v5
  v_and_b32 v54, v77, v6
  v_and_b32 v55, v77, v7
  s_waitcnt vmcnt(12)
  v_mfma_f32_16x16x32_bf16 v[24:27], v[48:51], v[144:147], v[24:27]
  v_and_b32 v48, v78, v4
  v_and_b32 v49, v78, v5
  v_and_b32 v50, v78, v6
  v_and_b32 v51, v78, v7
  v_mfma_f32_16x16x32_bf16 v[24:27], v[52:55], v[148:151], v[24:27]
  v_and_b32 v52, v79, v4
  v_and_b32 v53, v79, v5
  v_and_b32 v54, v79, v6
  v_and_b32 v55, v79, v7
  v_mfma_f32_16x16x32_bf16 v[24:27], v[48:51], v[152:155], v[24:27]
  s_nop 0
  v_mfma_f32_16x16x32_bf16 v[24:27], v[52:55], v[156:159], v[24:27]
  s_mov_b64 exec, s[66:67]
  buffer_load_dwordx4 v[144:147], v3, s[36:39], s52 offen offset:0 nt
  buffer_load_dwordx4 v[148:151], v3, s[36:39], s52 offen offset:256 nt
  buffer_load_dwordx4 v[152:155], v3, s[36:39], s52 offen offset:512 nt
  buffer_load_dwordx4 v[156:159], v3, s[36:39], s52 offen offset:768 nt
  s_add_u32 s52, s52, 16384
  s_mov_b64 exec, -1
  s_sub_u32 s53, s53, 1
  s_cmp_le_u32 s53, 7
  s_cbranch_scc1 L_near1
  s_branch L_loop
L_near0:
  s_cmp_eq_u32 s53, 0
  s_cbranch_scc1 L_done
  s_cmp_eq_u32 s18, 0
  s_cbranch_scc0 L_ph12_0
  s_cmp_eq_u32 s5, 0
  s_cbranch_scc0 L_nw0_0
  s_cmp_eq_u32 s53, 4
  s_cbranch_scc0 L_nreq_0
  v_mov_b32 v211, 1
  buffer_atomic_add v211, v31, s[40:43], 0 offen sc0 sc1
  s_branch L_cont0
L_nreq_0:
  s_cmp_eq_u32 s53, 2
  s_cbranch_scc0 L_nw0_0
  v_readfirstlane_b32 s63, v211
  v_mov_b32 v46, 0
  s_add_u32 s63, s63, 1
  v_mov_b32 v47, s63
  ds_write_b32 v46, v47 offset:29824
L_nw0_0:
  s_cmp_eq_u32 s53, 2
  s_cbranch_scc0 L_cont0
  s_mov_b32 s55, 4000000
  v_mov_b32 v46, 0
L_mb_0:
  ds_read_b32 v47, v46 offset:29824
  s_sub_u32 s55, s55, 1
  s_cmp_eq_u32 s55, 0
  s_cbranch_scc1 parallel_sum__gqa_block_cached__glu_gated_geglu__decode_kernel_end
  s_waitcnt lgkmcnt(0)
  v_readfirstlane_b32 s63, v47
  s_cmp_eq_u32 s63, 0
  s_cbranch_scc1 L_mb_0
  s_sub_u32 s63, s63, 1
  s_min_u32 s63, s63, 15
  s_mov_b32 s64, 0x16c6b9f1
  s_mov_b32 s65, 0
  s_cmp_ge_u32 s63, 6
  s_cselect_b32 s64, 0xe84a54b, s64
  s_cselect_b32 s65, 6, s65
  s_cmp_ge_u32 s63, 12
  s_cselect_b32 s64, 0x190c7, s64
  s_cselect_b32 s65, 12, s65
  s_sub_u32 s65, s63, s65
  s_mul_i32 s65, s65, 5
  s_lshr_b32 s64, s64, s65
  s_and_b32 s15, s64, 31
  s_mov_b32 s64, 0x2e201100
  s_cmp_ge_u32 s63, 4
  s_cselect_b32 s64, 0x5d52473b, s64
  s_cmp_ge_u32 s63, 8
  s_cselect_b32 s64, 0x81797067, s64
  s_cmp_ge_u32 s63, 12
  s_cselect_b32 s64, 0x99958f88, s64
  s_and_b32 s65, s63, 3
  s_lshl_b32 s65, s65, 3
  s_lshr_b32 s64, s64, s65
  s_and_b32 s14, s64, 255
  s_lshr_b32 s64, s13, 4
  s_add_u32 s15, s15, s64
  s_mul_i32 s64, s64, s63
  s_add_u32 s14, s14, s64
  s_and_b32 s64, s13, 15
  s_cmp_lt_u32 s63, s64
  s_addc_u32 s15, s15, 0
  s_min_u32 s64, s64, s63
  s_add_u32 s14, s14, s64
  s_sub_u32 s64, 3, s5
  s_add_u32 s14, s14, s64
  s_sub_u32 s15, s15, s64
  s_add_u32 s15, s15, 3
  s_ashr_i32 s15, s15, 2
  s_max_i32 s15, s15, 0
  s_add_u32 s53, s53, s15
  s_mov_b32 s18, 1
L_ph12_0:
  s_cmp_eq_u32 s18, 2
  s_cbranch_scc1 L_cont0
  s_cmp_gt_i32 s15, 0
  s_cbranch_scc0 L_nomore0
  s_mov_b32 s63, 233
  s_cmp_ge_u32 s14, 19
  s_cselect_b32 s63, 470, s63
  s_cmp_ge_u32 s14, 38
  s_cselect_b32 s63, 707, s63
  s_cmp_ge_u32 s14, 57
  s_cselect_b32 s63, s11, s63
  s_cmp_ge_u32 s14, s10
  s_cselect_b32 s63, s12, s63
  s_add_u32 s63, s63, s14
  s_sub_u32 s64, s14, s19
  s_lshr_b32 s65, s64, 2
  s_lshl_b32 s65, s65, 8
  s_and_b32 s64, s64, 3
  s_add_u32 s64, s64, s65
  s_add_u32 s64, s64, 252
  s_cmp_ge_u32 s14, s19
  s_cselect_b32 s63, s64, s63
  s_lshl_b32 s52, s63, 12
  s_add_u32 s14, s14, 4
  s_sub_u32 s15, s15, 1
  s_branch L_cont0
L_nomore0:
  s_mov_b32 s18, 2
  s_mov_b32 s52, 0x7fff0000
  s_mov_b64 s[66:67], 1
  s_branch L_cont0
L_near1:
  s_cmp_eq_u32 s53, 0
  s_cbranch_scc1 L_done
  s_cmp_eq_u32 s18, 0
  s_cbranch_scc0 L_ph12_1
  s_cmp_eq_u32 s5, 0
  s_cbranch_scc0 L_nw0_1
  s_cmp_eq_u32 s53, 4
  s_cbranch_scc0 L_nreq_1
  v_mov_b32 v211, 1
  buffer_atomic_add v211, v31, s[40:43], 0 offen sc0 sc1
  s_branch L_loop
L_nreq_1:
  s_cmp_eq_u32 s53, 2
  s_cbranch_scc0 L_nw0_1
  v_readfirstlane_b32 s63, v211
  v_mov_b32 v46, 0
  s_add_u32 s63, s63, 1
  v_mov_b32 v47, s63
  ds_write_b32 v46, v47 offset:29824
L_nw0_1:
  s_cmp_eq_u32 s53, 2
  s_cbranch_scc0 L_loop
  s_mov_b32 s55, 4000000
  v_mov_b32 v46, 0
L_mb_1:
  ds_read_b32 v47, v46 offset:29824
  s_sub_u32 s55, s55, 1
  s_cmp_eq_u32 s55, 0
  s_cbranch_scc1 parallel_sum__gqa_block_cached__glu_gated_geglu__decode_kernel_end
  s_waitcnt lgkmcnt(0)
  v_readfirstlane_b32 s63, v47
  s_cmp_eq_u32 s63, 0
  s_cbranch_scc1 L_mb_1
  s_sub_u32 s63, s63, 1
  s_min_u32 s63, s63, 15
  s_mov_b32 s64, 0x16c6b9f1
  s_mov_b32 s65, 0
  s_cmp_ge_u32 s63, 6
  s_cselect_b32 s64, 0xe84a54b, s64
  s_cselect_b32 s65, 6, s65
  s_cmp_ge_u32 s63, 12
  s_cselect_b32 s64, 0x190c7, s64
  s_cselect_b32 s65, 12, s65
  s_sub_u32 s65, s63, s65
  s_mul_i32 s65, s65, 5
  s_lshr_b32 s64, s64, s65
  s_and_b32 s15, s64, 31
  s_mov_b32 s64, 0x2e201100
  s_cmp_ge_u32 s63, 4
  s_cselect_b32 s64, 0x5d52473b, s64
  s_cmp_ge_u32 s63, 8
  s_cselect_b32 s64, 0x81797067, s64
  s_cmp_ge_u32 s63, 12
  s_cselect_b32 s64, 0x99958f88, s64
  s_and_b32 s65, s63, 3
  s_lshl_b32 s65, s65, 3
  s_lshr_b32 s64, s64, s65
  s_and_b32 s14, s64, 255
  s_lshr_b32 s64, s13, 4
  s_add_u32 s15, s15, s64
  s_mul_i32 s64, s64, s63
  s_add_u32 s14, s14, s64
  s_and_b32 s64, s13, 15
  s_cmp_lt_u32 s63, s64
  s_addc_u32 s15, s15, 0
  s_min_u32 s64, s64, s63
  s_add_u32 s14, s14, s64
  s_sub_u32 s64, 3, s5
  s_add_u32 s14, s14, s64
  s_sub_u32 s15, s15, s64
  s_add_u32 s15, s15, 3
  s_ashr_i32 s15, s15, 2
  s_max_i32 s15, s15, 0
  s_add_u32 s53, s53, s15
  s_mov_b32 s18, 1
L_ph12_1:
  s_cmp_eq_u32 s18, 2
  s_cbranch_scc1 L_loop
  s_cmp_gt_i32 s15, 0
  s_cbranch_scc0 L_nomore1
  s_mov_b32 s63, 233
  s_cmp_ge_u32 s14, 19
  s_cselect_b32 s63, 470, s63
  s_cmp_ge_u32 s14, 38
  s_cselect_b32 s63, 707, s63
  s_cmp_ge_u32 s14, 57
  s_cselect_b32 s63, s11, s63
  s_cmp_ge_u32 s14, s10
  s_cselect_b32 s63, s12, s63
  s_add_u32 s63, s63, s14
  s_sub_u32 s64, s14, s19
  s_lshr_b32 s65, s64, 2
  s_lshl_b32 s65, s65, 8
  s_and_b32 s64, s64, 3
  s_add_u32 s64, s64, s65
  s_add_u32 s64, s64, 252
  s_cmp_ge_u32 s14, s19
  s_cselect_b32 s63, s64, s63
  s_lshl_b32 s52, s63, 12
  s_add_u32 s14, s14, 4
  s_sub_u32 s15, s15, 1
  s_branch L_loop
L_nomore1:
  s_mov_b32 s18, 2
  s_mov_b32 s52, 0x7fff0000
  s_mov_b64 s[66:67], 1
  s_branch L_loop
L_slow0:
  v_mov_b32 v47, v46
  s_nop 1
  v_permlane16_swap_b32 v46, v47
  s_nop 1
  v_max_f32 v46, v46, v47
  v_mov_b32 v47, v46
  s_nop 1
  v_permlane32_swap_b32 v46, v47
  s_nop 1
  v_max_f32 v46, v46, v47
  v_max_f32 v46, v46, v28
  v_sub_f32 v47, v28, v46
  v_mul_f32 v47, s58, v47
  v_exp_f32 v47, v47
  v_mov_b32 v28, v46
  v_mul_f32 v29, s58, v46
  v_mul_f32 v30, v30, v47
  s_nop 1
  v_mov_b32_dpp v40, v47 row_newbcast:0 row_mask:0x3 bank_mask:0xf
  s_nop 1
  v_mov_b32_dpp v40, v47 row_newbcast:8 row_mask:0xc bank_mask:0xf
  s_nop 1
  v_mul_f32 v24, v24, v40
  v_mul_f32 v25, v25, v40
  v_mul_f32 v26, v26, v40
  v_mul_f32 v27, v27, v40
  s_branch L_back0
L_slow1:
  v_mov_b32 v47, v46
  s_nop 1
  v_permlane16_swap_b32 v46, v47
  s_nop 1
  v_max_f32 v46, v46, v47
  v_mov_b32 v47, v46
  s_nop 1
  v_permlane32_swap_b32 v46, v47
  s_nop 1
  v_max_f32 v46, v46, v47
  v_max_f32 v46, v46, v28
  v_sub_f32 v47, v28, v46
  v_mul_f32 v47, s58, v47
  v_exp_f32 v47, v47
  v_mov_b32 v28, v46
  v_mul_f32 v29, s58, v46
  v_mul_f32 v30, v30, v47
  s_nop 1
  v_mov_b32_dpp v40, v47 row_newbcast:0 row_mask:0x3 bank_mask:0xf
  s_nop 1
  v_mov_b32_dpp v40, v47 row_newbcast:8 row_mask:0xc bank_mask:0xf
  s_nop 1
  v_mul_f32 v24, v24, v40
  v_mul_f32 v25, v25, v40
  v_mul_f32 v26, v26, v40
  v_mul_f32 v27, v27, v40
  s_branch L_back1
L_done:
  buffer_load_dwordx4 a[224:227], v251, s[72:75], s61 offen offset:0 nt
  buffer_load_dwordx4 a[228:231], v251, s[72:75], s61 offen offset:256 nt
  buffer_load_dwordx4 a[232:235], v251, s[72:75], s61 offen offset:512 nt
  buffer_load_dwordx4 a[236:239], v251, s[72:75], s61 offen offset:768 nt
  buffer_load_dwordx4 a[240:243], v252, s[72:75], s61 offen offset:1024 nt
  v_mov_b32 v47, v30
  s_nop 1
  v_permlane16_swap_b32 v30, v47
  s_nop 1
  v_add_f32 v30, v30, v47
  v_mov_b32 v47, v30
  s_nop 1
  v_permlane32_swap_b32 v30, v47
  s_nop 1
  v_add_f32 v30, v30, v47
  ds_write_b128 v192, v[24:27] offset:15872
  v_mov_b32 v226, v29
  v_mov_b32 v227, v30
  s_mov_b32 exec_lo, 0x101
  s_mov_b32 exec_hi, 0
  ds_write_b64 v193, v[226:227] offset:19968
  s_mov_b64 exec, -1
  s_waitcnt lgkmcnt(0)
  s_barrier
  ds_read_b128 v[232:235], v195 offset:19968
  ds_read_b128 v[236:239], v195 offset:19984
  ds_read_b32 v228, v194 offset:15872
  ds_read_b32 v229, v194 offset:16896
  ds_read_b32 v230, v194 offset:17920
  ds_read_b32 v231, v194 offset:18944
  s_waitcnt lgkmcnt(4)
  v_max3_f32 v240, v232, v234, v236
  v_max_f32 v240, v240, v238
  v_sub_f32 v232, v232, v240
  v_sub_f32 v234, v234, v240
  v_sub_f32 v236, v236, v240
  v_sub_f32 v238, v238, v240
  v_exp_f32 v232, v232
  v_exp_f32 v234, v234
  v_exp_f32 v236, v236
  v_exp_f32 v238, v238
  s_waitcnt lgkmcnt(0)
  v_mul_f32 v242, v232, v228
  v_mul_f32 v243, v232, v233
  v_fmac_f32 v242, v234, v229
  v_fmac_f32 v243, v234, v235
  v_fmac_f32 v242, v236, v230
  v_fmac_f32 v243, v236, v237
  v_fmac_f32 v242, v238, v231
  v_fmac_f32 v243, v238, v239
  v_cndmask_b32 v212, v242, v240, s[68:69]
  s_nop 0
  v_mov_b32_dpp v214, v242 quad_perm:[1,0,3,2] row_mask:0xf bank_mask:0xf
  v_cndmask_b32 v214, v214, v243, s[68:69]
  buffer_store_dwordx4 v[212:215], v196, s[40:43], 0 offen sc1
  s_cmp_eq_u32 s59, 1
  s_cbranch_scc0 L_noffn2
  ds_read_b32 v232, v208 offset:14848
  ds_read_b32 v233, v208 offset:14864
  ds_read_b32 v234, v208 offset:14880
  ds_read_b32 v235, v208 offset:14896
  s_waitcnt lgkmcnt(0)
  v_and_b32 v48, v232, v4
  v_and_b32 v49, v232, v5
  v_and_b32 v50, v232, v6
  v_and_b32 v51, v232, v7
  s_nop 1
  v_mfma_f32_16x16x32_bf16 v[56:59], v[48:51], a[144:147], v[56:59]
  v_mfma_f32_16x16x32_bf16 v[60:63], v[48:51], a[148:151], v[60:63]
  v_mfma_f32_16x16x32_bf16 v[64:67], v[48:51], a[152:155], v[64:67]
  v_mfma_f32_16x16x32_bf16 v[68:71], v[48:51], a[156:159], v[68:71]
  v_mfma_f32_16x16x32_bf16 v[72:75], v[48:51], a[160:163], v[72:75]
  v_and_b32 v52, v233, v4
  v_and_b32 v53, v233, v5
  v_and_b32 v54, v233, v6
  v_and_b32 v55, v233, v7
  s_nop 1
  v_mfma_f32_16x16x32_bf16 v[56:59], v[52:55], a[164:167], v[56:59]
  v_mfma_f32_16x16x32_bf16 v[60:63], v[52:55], a[168:171], v[60:63]
  v_mfma_f32_16x16x32_bf16 v[64:67], v[52:55], a[172:175], v[64:67]
  v_mfma_f32_16x16x32_bf16 v[68:71], v[52:55], a[176:179], v[68:71]
  v_mfma_f32_16x16x32_bf16 v[72:75], v[52:55], a[180:183], v[72:75]
  v_and_b32 v48, v234, v4
  v_and_b32 v49, v234, v5
  v_and_b32 v50, v234, v6
  v_and_b32 v51, v234, v7
  s_nop 1
  v_mfma_f32_16x16x32_bf16 v[56:59], v[48:51], a[184:187], v[56:59]
  v_mfma_f32_16x16x32_bf16 v[60:63], v[48:51], a[188:191], v[60:63]
  v_mfma_f32_16x16x32_bf16 v[64:67], v[48:51], a[192:195], v[64:67]
  v_mfma_f32_16x16x32_bf16 v[68:71], v[48:51], a[196:199], v[68:71]
  v_mfma_f32_16x16x32_bf16 v[72:75], v[48:51], a[200:203], v[72:75]
  v_and_b32 v52, v235, v4
  v_and_b32 v53, v235, v5
  v_and_b32 v54, v235, v6
  v_and_b32 v55, v235, v7
  s_nop 1
  v_mfma_f32_16x16x32_bf16 v[56:59], v[52:55], a[204:207], v[56:59]
  v_mfma_f32_16x16x32_bf16 v[60:63], v[52:55], a[208:211], v[60:63]
  v_mfma_f32_16x16x32_bf16 v[64:67], v[52:55], a[212:215], v[64:67]
  v_mfma_f32_16x16x32_bf16 v[68:71], v[52:55], a[216:219], v[68:71]
  v_mfma_f32_16x16x32_bf16 v[72:75], v[52:55], a[220:223], v[72:75]
L_noffn2:
  s_mov_b32 s55, 400000
L_poll1:
  buffer_load_dwordx4 v[232:235], v197, s[40:43], 0 offen sc1
  buffer_load_dwordx4 v[236:239], v198, s[40:43], 0 offen sc1
  s_sub_u32 s55, s55, 1
  s_cmp_eq_u32 s55, 0
  s_cbranch_scc1 parallel_sum__gqa_block_cached__glu_gated_geglu__decode_kernel_end
  s_waitcnt vmcnt(0)
  v_xor_b32 v240, s76, v233
  v_xor_b32 v241, s77, v235
  v_or_b32 v240, v240, v241
  v_xor_b32 v241, s76, v237
  v_or_b32 v240, v240, v241
  v_xor_b32 v241, s77, v239
  v_or_b32 v240, v240, v241
  v_cmp_ne_u32 vcc, 0, v240
  s_cbranch_vccz L_poll1_ok
  s_mov_b64 exec, vcc
  s_branch L_poll1
L_poll1_ok:
  s_mov_b64 exec, -1
  v_mov_b32 v240, v236
  v_cndmask_b32 v232, v232, v234, s[70:71]
  s_nop 0
  v_max_f32_dpp v240, v240, v240 quad_perm:[1,0,3,2] row_mask:0xf bank_mask:0xf
  s_nop 1
  v_max_f32_dpp v240, v240, v240 quad_perm:[2,3,0,1] row_mask:0xf bank_mask:0xf
  s_nop 1
  v_max_f32_dpp v240, v240, v240 row_half_mirror row_mask:0xf bank_mask:0xf
  s_nop 1
  v_max_f32_dpp v240, v240, v240 row_mirror row_mask:0xf bank_mask:0xf
  v_sub_f32 v241, v236, v240
  v_exp_f32 v241, v241
  s_nop 0
  v_mul_f32 v242, v241, v232
  v_mul_f32 v243, v241, v238
  s_nop 0
  v_add_f32_dpp v242, v242, v242 quad_perm:[1,0,3,2] row_mask:0xf bank_mask:0xf
  v_add_f32_dpp v243, v243, v243 quad_perm:[1,0,3,2] row_mask:0xf bank_mask:0xf
  s_nop 0
  v_add_f32_dpp v242, v242, v242 quad_perm:[2,3,0,1] row_mask:0xf bank_mask:0xf
  v_add_f32_dpp v243, v243, v243 quad_perm:[2,3,0,1] row_mask:0xf bank_mask:0xf
  s_nop 0
  v_add_f32_dpp v242, v242, v242 row_half_mirror row_mask:0xf bank_mask:0xf
  v_add_f32_dpp v243, v243, v243 row_half_mirror row_mask:0xf bank_mask:0xf
  s_nop 0
  v_add_f32_dpp v242, v242, v242 row_mirror row_mask:0xf bank_mask:0xf
  v_add_f32_dpp v243, v243, v243 row_mirror row_mask:0xf bank_mask:0xf
  v_rcp_f32 v241, v243
  s_nop 0
  v_mul_f32 v240, v242, v241
  v_cvt_pk_bf16_f32 v240, v240, v240
  v_and_b32 v48, v240, v4
  v_and_b32 v49, v240, v5
  v_and_b32 v50, v240, v6
  v_and_b32 v51, v240, v7
  s_nop 1
  v_mfma_f32_16x16x32_bf16 v[56:59], v[48:51], a[224:227], v[56:59]
  v_mfma_f32_16x16x32_bf16 v[60:63], v[48:51], a[228:231], v[60:63]
  v_mfma_f32_16x16x32_bf16 v[64:67], v[48:51], a[232:235], v[64:67]
  v_mfma_f32_16x16x32_bf16 v[68:71], v[48:51], a[236:239], v[68:71]
  v_mfma_f32_16x16x32_bf16 v[72:75], v[48:51], a[240:243], v[72:75]
  s_mov_b32 exec_lo, 0xffffffff
  s_mov_b32 exec_hi, 0
  s_nop 1
  ds_write_b128 v199, v[56:59] offset:20096
  ds_write_b128 v199, v[60:63] offset:20608
  ds_write_b128 v199, v[64:67] offset:21120
  ds_write_b128 v199, v[68:71] offset:21632
  s_mov_b32 exec_lo, 0x00ff00ff
  s_mov_b32 exec_hi, 0
  s_nop 1
  ds_write_b128 v199, v[72:75] offset:22144
  s_mov_b64 exec, -1
  s_waitcnt lgkmcnt(0)
  s_barrier
  ds_read_b128 v[228:231], v200 offset:20096
  ds_read_b128 v[232:235], v200 offset:22400
  ds_read_b128 v[236:239], v200 offset:24704
  ds_read_b128 v[240:243], v200 offset:27008
  s_waitcnt lgkmcnt(2)
  v_pk_add_f32 v[228:229], v[228:229], v[232:233]
  v_pk_add_f32 v[230:231], v[230:231], v[234:235]
  s_waitcnt lgkmcnt(0)
  v_pk_add_f32 v[236:237], v[236:237], v[240:241]
  v_pk_add_f32 v[238:239], v[238:239], v[242:243]
  v_pk_add_f32 v[228:229], v[228:229], v[236:237]
  v_pk_add_f32 v[230:231], v[230:231], v[238:239]
  v_add_u32 v228, 0x800, v228
  v_add_u32 v229, 0x800, v229
  v_add_u32 v230, 0x800, v230
  v_add_u32 v231, 0x800, v231
  v_and_or_b32 v216, v228, v203, s20
  v_and_or_b32 v217, v229, v203, s21
  v_and_or_b32 v218, v230, v203, s22
  v_and_or_b32 v219, v231, v203, s23
  buffer_store_dwordx4 v[216:219], v202, s[40:43], 0 offen sc1
  s_cmp_ge_u32 s2, 18
  s_cbranch_scc1 parallel_sum__gqa_block_cached__glu_gated_geglu__decode_kernel_end
  s_mov_b32 s61, 4096
  s_mov_b32 s62, 8192
  s_mov_b32 s63, 12288
  s_mov_b32 s64, 16384
  s_mov_b32 s65, 20480
  s_mov_b32 s66, 24576
  s_mov_b32 s67, 28672
  s_mov_b32 s55, 400000
L_poll2:
  buffer_load_dwordx4 v[224:227], v204, s[40:43], 0 offen sc1
  buffer_load_dwordx4 v[228:231], v204, s[40:43], s61 offen sc1
  buffer_load_dwordx4 v[232:235], v204, s[40:43], s62 offen sc1
  buffer_load_dwordx4 v[236:239], v204, s[40:43], s63 offen sc1
  buffer_load_dwordx4 v[240:243], v204, s[40:43], s64 offen sc1
  buffer_load_dwordx4 v[244:247], v204, s[40:43], s65 offen sc1
  buffer_load_dwordx4 v[248:251], v204, s[40:43], s66 offen sc1
  buffer_load_dwordx4 v[252:255], v204, s[40:43], s67 offen sc1
  s_sub_u32 s55, s55, 1
  s_cmp_eq_u32 s55, 0
  s_cbranch_scc1 parallel_sum__gqa_block_cached__glu_gated_geglu__decode_kernel_end
  s_waitcnt vmcnt(7)
  v_subrev_u32 v224, s20, v224
  v_subrev_u32 v225, s21, v225
  v_subrev_u32 v226, s22, v226
  v_subrev_u32 v227, s23, v227
  v_or_b32 v210, v224, v225
  v_or3_b32 v210, v210, v226, v227
  s_waitcnt vmcnt(6)
  v_subrev_u32 v228, s20, v228
  v_subrev_u32 v229, s21, v229
  v_subrev_u32 v230, s22, v230
  v_subrev_u32 v231, s23, v231
  v_or3_b32 v210, v210, v228, v229
  v_or3_b32 v210, v210, v230, v231
  s_waitcnt vmcnt(5)
  v_subrev_u32 v232, s20, v232
  v_subrev_u32 v233, s21, v233
  v_subrev_u32 v234, s22, v234
  v_subrev_u32 v235, s23, v235
  v_or3_b32 v210, v210, v232, v233
  v_or3_b32 v210, v210, v234, v235
  s_waitcnt vmcnt(4)
  v_subrev_u32 v236, s20, v236
  v_subrev_u32 v237, s21, v237
  v_subrev_u32 v238, s22, v238
  v_subrev_u32 v239, s23, v239
  v_or3_b32 v210, v210, v236, v237
  v_or3_b32 v210, v210, v238, v239
  s_waitcnt vmcnt(3)
  v_subrev_u32 v240, s20, v240
  v_subrev_u32 v241, s21, v241
  v_subrev_u32 v242, s22, v242
  v_subrev_u32 v243, s23, v243
  v_or3_b32 v210, v210, v240, v241
  v_or3_b32 v210, v210, v242, v243
  s_waitcnt vmcnt(2)
  v_subrev_u32 v244, s20, v244
  v_subrev_u32 v245, s21, v245
  v_subrev_u32 v246, s22, v246
  v_subrev_u32 v247, s23, v247
  v_or3_b32 v210, v210, v244, v245
  v_or3_b32 v210, v210, v246, v247
  s_waitcnt vmcnt(1)
  v_subrev_u32 v248, s20, v248
  v_subrev_u32 v249, s21, v249
  v_subrev_u32 v250, s22, v250
  v_subrev_u32 v251, s23, v251
  v_or3_b32 v210, v210, v248, v249
  v_or3_b32 v210, v210, v250, v251
  s_waitcnt vmcnt(0)
  v_subrev_u32 v252, s20, v252
  v_subrev_u32 v253, s21, v253
  v_subrev_u32 v254, s22, v254
  v_subrev_u32 v255, s23, v255
  v_or3_b32 v210, v210, v252, v253
  v_or3_b32 v210, v210, v254, v255
  v_and_b32 v210, 0xfff, v210
  v_cmp_ne_u32 vcc, 0, v210
  s_cbranch_vccz L_poll2_ok
  s_mov_b64 exec, vcc
  s_branch L_poll2
L_poll2_ok:
  s_mov_b64 exec, -1
  v_pk_add_f32 v[224:225], v[224:225], v[240:241]
  v_pk_add_f32 v[226:227], v[226:227], v[242:243]
  v_pk_add_f32 v[228:229], v[228:229], v[244:245]
  v_pk_add_f32 v[230:231], v[230:231], v[246:247]
  v_pk_add_f32 v[232:233], v[232:233], v[248:249]
  v_pk_add_f32 v[234:235], v[234:235], v[250:251]
  v_pk_add_f32 v[236:237], v[236:237], v[252:253]
  v_pk_add_f32 v[238:239], v[238:239], v[254:255]
  v_pk_add_f32 v[224:225], v[224:225], v[232:233]
  v_pk_add_f32 v[226:227], v[226:227], v[234:235]
  v_pk_add_f32 v[228:229], v[228:229], v[236:237]
  v_pk_add_f32 v[230:231], v[230:231], v[238:239]
  v_pk_add_f32 v[224:225], v[224:225], v[228:229]
  v_pk_add_f32 v[226:227], v[226:227], v[230:231]
  s_nop 0
  v_add_f32_dpp v224, v224, v224 row_ror:8 row_mask:0xf bank_mask:0xf
  v_add_f32_dpp v225, v225, v225 row_ror:8 row_mask:0xf bank_mask:0xf
  v_add_f32_dpp v226, v226, v226 row_ror:8 row_mask:0xf bank_mask:0xf
  v_add_f32_dpp v227, v227, v227 row_ror:8 row_mask:0xf bank_mask:0xf
  v_mov_b32 v228, v224
  v_mov_b32 v229, v225
  v_mov_b32 v230, v226
  v_mov_b32 v231, v227
  s_nop 0
  v_permlane16_swap_b32 v224, v228
  v_permlane16_swap_b32 v225, v229
  v_permlane16_swap_b32 v226, v230
  v_permlane16_swap_b32 v227, v231
  s_nop 0
  v_add_f32 v224, v224, v228
  v_add_f32 v225, v225, v229
  v_add_f32 v226, v226, v230
  v_add_f32 v227, v227, v231
  v_mov_b32 v228, v224
  v_mov_b32 v229, v225
  v_mov_b32 v230, v226
  v_mov_b32 v231, v227
  s_nop 0
  v_permlane32_swap_b32 v224, v228
  v_permlane32_swap_b32 v225, v229
  v_permlane32_swap_b32 v226, v230
  v_permlane32_swap_b32 v227, v231
  s_nop 0
  v_add_f32 v224, v224, v228
  v_add_f32 v225, v225, v229
  v_add_f32 v226, v226, v230
  v_add_f32 v227, v227, v231
  s_mov_b32 exec_lo, 0xff
  s_mov_b32 exec_hi, 0
  ds_write_b128 v206, v[224:227] offset:29312
  s_mov_b64 exec, -1
  v_lshlrev_b32 v209, 16, v209
  s_waitcnt lgkmcnt(0)
  s_barrier
  s_cmp_eq_u32 s5, 0
  s_cbranch_scc0 parallel_sum__gqa_block_cached__glu_gated_geglu__decode_kernel_end
  ds_read_b32 v228, v207 offset:29312
  ds_read_b32 v229, v207 offset:29440
  ds_read_b32 v230, v207 offset:29568
  ds_read_b32 v231, v207 offset:29696
  s_waitcnt lgkmcnt(0)
  v_add_f32 v228, v228, v229
  v_add_f32 v230, v230, v231
  v_add_f32 v228, v228, v209
  v_add_f32 v228, v228, v230
  v_cvt_pk_bf16_f32 v228, v228, v228
  s_mov_b32 exec_lo, 0xffffffff
  s_mov_b32 exec_hi, 0
  buffer_store_short v228, v205, s[48:51], 0 offen
  s_cmp_eq_u32 s2, 0
  s_cbranch_scc0 parallel_sum__gqa_block_cached__glu_gated_geglu__decode_kernel_end
  v_mov_b32 v232, s76
  v_mov_b32 v233, s77
  v_mov_b32 v234, 0
  s_mov_b32 exec_lo, 1
  s_mov_b32 exec_hi, 0
  buffer_store_dwordx2 v[232:233], v234, s[40:43], 0 offen offset:0 sc1
parallel_sum__gqa_block_cached__glu_gated_geglu__decode_kernel_end:
parallel_sum__gqa_block_cached__glu_gated_geglu__decode_kernel_endx:
  s_endpgm
.section .rodata,"a"
.p2align 6
.amdhsa_kernel parallel_sum__gqa_block_cached__glu_gated_geglu__decode_kernel
  .amdhsa_next_free_vgpr 512
  .amdhsa_next_free_sgpr 102
  .amdhsa_accum_offset 256
  .amdhsa_group_segment_fixed_size 0
  .amdhsa_kernarg_size 96
  .amdhsa_user_sgpr_count 2
  .amdhsa_user_sgpr_kernarg_segment_ptr 1
  .amdhsa_system_sgpr_workgroup_id_x 1
.end_amdhsa_kernel
.text
```
